```python
import torch

def _softmax(x, axis=-1):
    return torch.softmax(x, dim=axis)
def _gelu(x):
    return torch.nn.functional.gelu(x, approximate="tanh")
def _silu(x):
    return torch.nn.functional.silu(x)
def _sigmoid(x):
    return torch.sigmoid(x)
def _layernorm(x, axis=-1, eps=1e-5):
    m = x.mean(dim=axis, keepdim=True)
    v = x.var(dim=axis, keepdim=True, unbiased=False)
    return (x - m) / torch.sqrt(v + eps)
def _scatter_add(tgt, idx, src, axis=0):
    return tgt.clone().index_add_(axis, idx, src)
def _segment_sum(src, seg, n):
    out = torch.zeros((n,) + src.shape[1:], dtype=src.dtype)
    return out.index_add_(0, seg, src)
def _pad(x, pw):
    flat = tuple(v for pair in reversed(pw) for v in pair)
    return torch.nn.functional.pad(x, flat)

kernel_name = 'recurrent_scan__sliding_block_cached__glu_gated_reglu__decode'

def setup_inputs():

    _w = (lambda a: (lambda t: t.to(torch.bfloat16) if t.is_floating_point() else t)(torch.as_tensor(a)))
    def _A_setup():
        B, Sq, D = 1, 1, 640
        Hq, Hkv, Sk, Dh = 32, 32, 32768, 192
        assert Hq % Hkv == 0, (Hq, Hkv)
        return {
            "x": _w((lambda *s: torch.randn(*s, dtype=torch.bfloat16) * 0.2)(B, Sq, D)),
            "k_cache": _w((lambda *s: torch.randn(*s, dtype=torch.bfloat16) * 1.6)(B, Hkv, Sk, Dh)),
            "v_cache": _w((lambda *s: torch.randn(*s, dtype=torch.bfloat16) * 1.6)(B, Hkv, Sk, Dh)),
            "wq": _w((lambda *s: torch.randn(*s, dtype=torch.bfloat16) * 1.6)(D, Hq * Dh) * (D ** -0.5)),
            "wo": _w((lambda *s: torch.randn(*s, dtype=torch.bfloat16) * 1.6)(Hq * Dh, D) * ((Hq * Dh) ** -0.5)),
        }
    _A_in = _A_setup()

    def _B_setup():
        B, S, D, F = 1, 1, 640, 1536
        return {
            "x": _w((lambda *s: torch.randn(*s, dtype=torch.bfloat16) * 0.2)(B, S, D)),
            "W_gate": _w((lambda *s: torch.randn(*s, dtype=torch.bfloat16) * 0.8)(D, F) * (2.0 / D) ** 0.5),
            "W_up": _w((lambda *s: torch.randn(*s, dtype=torch.bfloat16) * 0.8)(D, F) * (2.0 / D) ** 0.5),
            "W_down": _w((lambda *s: torch.randn(*s, dtype=torch.bfloat16) * 0.8)(F, D) * (1.0 / F) ** 0.5),
        }
    _B_in = _B_setup()

    return {
        "A_x": _A_in["x"],
        "A_k_cache": _A_in["k_cache"],
        "A_v_cache": _A_in["v_cache"],
        "A_wq": _A_in["wq"],
        "A_wo": _A_in["wo"],
        "B_x": _B_in["x"],
        "B_W_gate": _B_in["W_gate"],
        "B_W_up": _B_in["W_up"],
        "B_W_down": _B_in["W_down"],
    }

def reference(A_x, A_k_cache, A_v_cache, A_wq, A_wo, B_x, B_W_gate, B_W_up, B_W_down):
    def _A_ref(x, k_cache, v_cache, wq, wo):
        B, Sq, D = x.shape
        Hq, Dh = 32, 192
        Hkv, Sk = k_cache.shape[1], k_cache.shape[2]
        W = min(4096, max(256, Sk // 4))
        rep = Hq // Hkv
        q = (lambda x, *d: x.permute(*d))((x @ wq).reshape(B, Sq, Hq, Dh), 0, 2, 1, 3)
        k = (lambda x, n, axis: torch.repeat_interleave(x, n, dim=axis))(k_cache[:, :, Sk - W:, :], rep, axis=1)
        v = (lambda x, n, axis: torch.repeat_interleave(x, n, dim=axis))(v_cache[:, :, Sk - W:, :], rep, axis=1)
        scores = torch.einsum("bhqd,bhkd->bhqk", q, k) * (Dh ** -0.5)
        p = _softmax(scores, axis=-1)
        o = torch.einsum("bhqk,bhkd->bhqd", p, v)
        return (lambda x, *d: x.permute(*d))(o, 0, 2, 1, 3).reshape(B, Sq, Hq * Dh) @ wo

    def _B_ref(x, W_gate, W_up, W_down):
        gate = torch.einsum("bsd,df->bsf", x, W_gate)
        up = torch.einsum("bsd,df->bsf", x, W_up)
        gate = gate * (lambda x, dt: x.to(dt))(gate > 0, gate.dtype)
        h = gate * up
        return torch.einsum("bsf,fd->bsd", h, W_down)

    x = A_x
    xn = _layernorm(x, axis=-1)
    s = _A_ref(xn, A_k_cache, A_v_cache, A_wq, A_wo)
    g = _silu(_B_ref(xn, B_W_gate, B_W_up, B_W_down))
    return x + s * g
```

```asm
; @launch grid=(256,1,1) block=(768,1,1) lds=46208
.amdgcn_target "amdgcn-amd-amdhsa--gfx950"
.text
.globl recurrent_scan__sliding_block_cached__glu_gated_reglu__decode_kernel
.p2align 8
.type recurrent_scan__sliding_block_cached__glu_gated_reglu__decode_kernel,@function
recurrent_scan__sliding_block_cached__glu_gated_reglu__decode_kernel:
  s_cmp_ge_u32 s2, 256
  s_cbranch_scc1 L_end
  s_load_dwordx16 s[8:23], s[0:1], 0
  s_load_dwordx8 s[24:31], s[0:1], 64
  v_readfirstlane_b32 s3, v0
  v_and_b32 v0, 63, v0
  s_lshr_b32 s3, s3, 6
  s_and_b32 s4, s2, 7
  s_lshl_b32 s4, s4, 2
  s_lshr_b32 s5, s2, 3
  s_and_b32 s5, s5, 3
  s_add_u32 s4, s4, s5
  s_lshr_b32 s5, s2, 5
  s_cmp_ge_u32 s3, 8
  s_cbranch_scc1 L_helper
  s_mul_i32 s6, s4, 12582912
  s_mul_i32 s7, s5, 12288
  s_add_u32 s6, s6, s7
  s_add_u32 s6, s6, 11010048
  s_mul_i32 s7, s3, 1536
  v_lshrrev_b32 v3, 4, v0
  v_and_b32 v2, 15, v0
  v_mul_u32_u24 v3, 384, v3
  v_add_u32 v3, s7, v3
  v_lshl_add_u32 v1, v2, 4, v3
  v_lshl_add_u32 v2, v2, 3, v3
  v_add_u32 v2, 256, v2
  s_mov_b32 s60, 4608
  s_mov_b32 s61, 9216
  s_mov_b32 s62, 13824
  s_mov_b32 s63, 18432
  s_mov_b32 s64, 23040
  s_waitcnt lgkmcnt(0)
  s_add_u32 s32, s10, s6
  s_addc_u32 s33, s11, 0
  s_mov_b32 s34, 1486848
  s_mov_b32 s35, 0x20000
  s_add_u32 s36, s12, s6
  s_addc_u32 s37, s13, 0
  s_mov_b32 s38, 1486848
  s_mov_b32 s39, 0x20000
  buffer_load_dwordx4 v[42:45], v1, s[32:35], 0 offen nt
  buffer_load_dwordx2 v[46:47], v2, s[32:35], 0 offen nt
  s_mov_b32 s60, 98304
  buffer_load_dwordx4 v[48:51], v1, s[32:35], s60 offen nt
  buffer_load_dwordx2 v[52:53], v2, s[32:35], s60 offen nt
  s_barrier
  s_waitcnt vmcnt(2)
  s_mov_b32 s60, 196608
  buffer_load_dwordx4 v[54:57], v1, s[32:35], s60 offen nt
  buffer_load_dwordx2 v[58:59], v2, s[32:35], s60 offen nt
  s_waitcnt vmcnt(2)
  s_mov_b32 s60, 294912
  buffer_load_dwordx4 v[60:63], v1, s[32:35], s60 offen nt
  buffer_load_dwordx2 v[64:65], v2, s[32:35], s60 offen nt
  s_waitcnt vmcnt(2)
  s_mov_b32 s60, 393216
  buffer_load_dwordx4 v[66:69], v1, s[32:35], s60 offen nt
  buffer_load_dwordx2 v[70:71], v2, s[32:35], s60 offen nt
  s_waitcnt vmcnt(2)
  s_mov_b32 s60, 491520
  buffer_load_dwordx4 v[72:75], v1, s[32:35], s60 offen nt
  buffer_load_dwordx2 v[76:77], v2, s[32:35], s60 offen nt
  s_mov_b32 s60, 589824
  buffer_load_dwordx4 v[78:81], v1, s[32:35], s60 offen nt
  buffer_load_dwordx2 v[82:83], v2, s[32:35], s60 offen nt
  s_waitcnt vmcnt(4)
  s_mov_b32 s60, 688128
  buffer_load_dwordx4 v[84:87], v1, s[32:35], s60 offen nt
  buffer_load_dwordx2 v[88:89], v2, s[32:35], s60 offen nt
  s_waitcnt vmcnt(4)
  s_mov_b32 s60, 786432
  buffer_load_dwordx4 v[90:93], v1, s[32:35], s60 offen nt
  buffer_load_dwordx2 v[94:95], v2, s[32:35], s60 offen nt
  s_waitcnt vmcnt(4)
  s_mov_b32 s60, 884736
  buffer_load_dwordx4 v[96:99], v1, s[32:35], s60 offen nt
  buffer_load_dwordx2 v[100:101], v2, s[32:35], s60 offen nt
  s_waitcnt vmcnt(4)
  s_mov_b32 s60, 983040
  buffer_load_dwordx4 v[102:105], v1, s[32:35], s60 offen nt
  buffer_load_dwordx2 v[106:107], v2, s[32:35], s60 offen nt
  v_mov_b32 v41, 0
  s_mov_b32 s57, 0
L_qf_1:
  ds_read_b32 v40, v41 offset:392
  s_waitcnt lgkmcnt(0)
  v_readfirstlane_b32 s58, v40
  s_add_u32 s57, s57, 1
  s_cmp_gt_u32 s57, 240000
  s_cbranch_scc1 L_qfd_2
  s_cmp_eq_u32 s58, 3
  s_cbranch_scc1 L_qfd_2
  s_sleep 1
  s_branch L_qf_1
L_qfd_2:
  v_and_b32 v40, 15, v0
  v_lshlrev_b32 v41, 4, v40
  v_lshlrev_b32 v40, 3, v40
  ds_read_b128 v[4:7], v41 offset:0
  ds_read_b64 v[8:9], v40 offset:256
  s_waitcnt lgkmcnt(0)
  v_dot2_f32_bf16 v22, v42, v4, 0
  v_dot2_f32_bf16 v23, v48, v4, 0
  v_dot2_f32_bf16 v24, v54, v4, 0
  v_dot2_f32_bf16 v25, v60, v4, 0
  v_dot2_f32_bf16 v22, v43, v5, v22
  v_dot2_f32_bf16 v23, v49, v5, v23
  v_dot2_f32_bf16 v24, v55, v5, v24
  v_dot2_f32_bf16 v25, v61, v5, v25
  v_dot2_f32_bf16 v22, v44, v6, v22
  v_dot2_f32_bf16 v23, v50, v6, v23
  v_dot2_f32_bf16 v24, v56, v6, v24
  v_dot2_f32_bf16 v25, v62, v6, v25
  v_dot2_f32_bf16 v22, v45, v7, v22
  v_dot2_f32_bf16 v23, v51, v7, v23
  v_dot2_f32_bf16 v24, v57, v7, v24
  v_dot2_f32_bf16 v25, v63, v7, v25
  v_dot2_f32_bf16 v22, v46, v8, v22
  v_dot2_f32_bf16 v23, v52, v8, v23
  v_dot2_f32_bf16 v24, v58, v8, v24
  v_dot2_f32_bf16 v25, v64, v8, v25
  v_dot2_f32_bf16 v22, v47, v9, v22
  v_dot2_f32_bf16 v23, v53, v9, v23
  v_dot2_f32_bf16 v24, v59, v9, v24
  v_dot2_f32_bf16 v25, v65, v9, v25
  v_add_f32_dpp v26, v22, v22 row_ror:8 row_mask:0xf bank_mask:0x3
  v_add_f32_dpp v27, v23, v23 row_ror:8 row_mask:0xf bank_mask:0x3
  s_nop 0
  v_add_f32_dpp v26, v24, v24 row_ror:8 row_mask:0xf bank_mask:0xc
  v_add_f32_dpp v27, v25, v25 row_ror:8 row_mask:0xf bank_mask:0xc
  s_nop 0
  v_add_f32_dpp v28, v26, v26 row_shl:4 row_mask:0xf bank_mask:0x5
  s_nop 1
  v_add_f32_dpp v28, v27, v27 row_shr:4 row_mask:0xf bank_mask:0xa
  s_nop 1
  v_add_f32_dpp v28, v28, v28 quad_perm:[1,0,3,2] row_mask:0xf bank_mask:0xf
  s_nop 1
  v_add_f32_dpp v28, v28, v28 quad_perm:[2,3,0,1] row_mask:0xf bank_mask:0xf
  v_dot2_f32_bf16 v22, v66, v4, 0
  v_dot2_f32_bf16 v23, v72, v4, 0
  v_dot2_f32_bf16 v24, v78, v4, 0
  v_dot2_f32_bf16 v25, v84, v4, 0
  v_dot2_f32_bf16 v22, v67, v5, v22
  v_dot2_f32_bf16 v23, v73, v5, v23
  v_dot2_f32_bf16 v24, v79, v5, v24
  v_dot2_f32_bf16 v25, v85, v5, v25
  v_dot2_f32_bf16 v22, v68, v6, v22
  v_dot2_f32_bf16 v23, v74, v6, v23
  v_dot2_f32_bf16 v24, v80, v6, v24
  v_dot2_f32_bf16 v25, v86, v6, v25
  v_dot2_f32_bf16 v22, v69, v7, v22
  v_dot2_f32_bf16 v23, v75, v7, v23
  v_dot2_f32_bf16 v24, v81, v7, v24
  v_dot2_f32_bf16 v25, v87, v7, v25
  v_dot2_f32_bf16 v22, v70, v8, v22
  v_dot2_f32_bf16 v23, v76, v8, v23
  v_dot2_f32_bf16 v24, v82, v8, v24
  v_dot2_f32_bf16 v25, v88, v8, v25
  v_dot2_f32_bf16 v22, v71, v9, v22
  v_dot2_f32_bf16 v23, v77, v9, v23
  v_dot2_f32_bf16 v24, v83, v9, v24
  v_dot2_f32_bf16 v25, v89, v9, v25
  v_add_f32_dpp v26, v22, v22 row_ror:8 row_mask:0xf bank_mask:0x3
  v_add_f32_dpp v27, v23, v23 row_ror:8 row_mask:0xf bank_mask:0x3
  s_nop 0
  v_add_f32_dpp v26, v24, v24 row_ror:8 row_mask:0xf bank_mask:0xc
  v_add_f32_dpp v27, v25, v25 row_ror:8 row_mask:0xf bank_mask:0xc
  s_nop 0
  v_add_f32_dpp v29, v26, v26 row_shl:4 row_mask:0xf bank_mask:0x5
  s_nop 1
  v_add_f32_dpp v29, v27, v27 row_shr:4 row_mask:0xf bank_mask:0xa
  s_nop 1
  v_add_f32_dpp v29, v29, v29 quad_perm:[1,0,3,2] row_mask:0xf bank_mask:0xf
  s_nop 1
  v_add_f32_dpp v29, v29, v29 quad_perm:[2,3,0,1] row_mask:0xf bank_mask:0xf
  s_waitcnt vmcnt(4)
  s_mov_b32 s60, 1081344
  buffer_load_dwordx4 v[108:111], v1, s[32:35], s60 offen nt
  buffer_load_dwordx2 v[112:113], v2, s[32:35], s60 offen nt
  s_waitcnt vmcnt(4)
  s_mov_b32 s60, 1179648
  buffer_load_dwordx4 v[114:117], v1, s[32:35], s60 offen nt
  buffer_load_dwordx2 v[118:119], v2, s[32:35], s60 offen nt
  s_waitcnt vmcnt(4)
  s_mov_b32 s60, 1277952
  buffer_load_dwordx4 v[120:123], v1, s[32:35], s60 offen nt
  buffer_load_dwordx2 v[124:125], v2, s[32:35], s60 offen nt
  s_waitcnt vmcnt(4)
  s_mov_b32 s60, 1376256
  buffer_load_dwordx4 v[126:129], v1, s[32:35], s60 offen nt
  buffer_load_dwordx2 v[130:131], v2, s[32:35], s60 offen nt
  v_dot2_f32_bf16 v22, v90, v4, 0
  v_dot2_f32_bf16 v23, v96, v4, 0
  v_dot2_f32_bf16 v24, v102, v4, 0
  v_dot2_f32_bf16 v25, v108, v4, 0
  v_dot2_f32_bf16 v22, v91, v5, v22
  v_dot2_f32_bf16 v23, v97, v5, v23
  v_dot2_f32_bf16 v24, v103, v5, v24
  v_dot2_f32_bf16 v25, v109, v5, v25
  v_dot2_f32_bf16 v22, v92, v6, v22
  v_dot2_f32_bf16 v23, v98, v6, v23
  v_dot2_f32_bf16 v24, v104, v6, v24
  v_dot2_f32_bf16 v25, v110, v6, v25
  v_dot2_f32_bf16 v22, v93, v7, v22
  v_dot2_f32_bf16 v23, v99, v7, v23
  v_dot2_f32_bf16 v24, v105, v7, v24
  v_dot2_f32_bf16 v25, v111, v7, v25
  v_dot2_f32_bf16 v22, v94, v8, v22
  v_dot2_f32_bf16 v23, v100, v8, v23
  v_dot2_f32_bf16 v24, v106, v8, v24
  v_dot2_f32_bf16 v25, v112, v8, v25
  v_dot2_f32_bf16 v22, v95, v9, v22
  v_dot2_f32_bf16 v23, v101, v9, v23
  v_dot2_f32_bf16 v24, v107, v9, v24
  v_dot2_f32_bf16 v25, v113, v9, v25
  v_add_f32_dpp v26, v22, v22 row_ror:8 row_mask:0xf bank_mask:0x3
  v_add_f32_dpp v27, v23, v23 row_ror:8 row_mask:0xf bank_mask:0x3
  s_nop 0
  v_add_f32_dpp v26, v24, v24 row_ror:8 row_mask:0xf bank_mask:0xc
  v_add_f32_dpp v27, v25, v25 row_ror:8 row_mask:0xf bank_mask:0xc
  s_nop 0
  v_add_f32_dpp v30, v26, v26 row_shl:4 row_mask:0xf bank_mask:0x5
  s_nop 1
  v_add_f32_dpp v30, v27, v27 row_shr:4 row_mask:0xf bank_mask:0xa
  s_nop 1
  v_add_f32_dpp v30, v30, v30 quad_perm:[1,0,3,2] row_mask:0xf bank_mask:0xf
  s_nop 1
  v_add_f32_dpp v30, v30, v30 quad_perm:[2,3,0,1] row_mask:0xf bank_mask:0xf
  s_waitcnt vmcnt(4)
  s_mov_b32 s60, 1474560
  buffer_load_dwordx4 v[132:135], v1, s[32:35], s60 offen nt
  buffer_load_dwordx2 v[136:137], v2, s[32:35], s60 offen nt
  s_waitcnt vmcnt(4)
  buffer_load_dwordx4 v[138:141], v1, s[36:39], 0 offen nt
  buffer_load_dwordx2 v[142:143], v2, s[36:39], 0 offen nt
  s_waitcnt vmcnt(4)
  s_mov_b32 s60, 98304
  buffer_load_dwordx4 v[144:147], v1, s[36:39], s60 offen nt
  buffer_load_dwordx2 v[148:149], v2, s[36:39], s60 offen nt
  s_waitcnt vmcnt(4)
  s_mov_b32 s60, 196608
  buffer_load_dwordx4 v[150:153], v1, s[36:39], s60 offen nt
  buffer_load_dwordx2 v[154:155], v2, s[36:39], s60 offen nt
  v_dot2_f32_bf16 v22, v114, v4, 0
  v_dot2_f32_bf16 v23, v120, v4, 0
  v_dot2_f32_bf16 v24, v126, v4, 0
  v_dot2_f32_bf16 v25, v132, v4, 0
  v_dot2_f32_bf16 v22, v115, v5, v22
  v_dot2_f32_bf16 v23, v121, v5, v23
  v_dot2_f32_bf16 v24, v127, v5, v24
  v_dot2_f32_bf16 v25, v133, v5, v25
  v_dot2_f32_bf16 v22, v116, v6, v22
  v_dot2_f32_bf16 v23, v122, v6, v23
  v_dot2_f32_bf16 v24, v128, v6, v24
  v_dot2_f32_bf16 v25, v134, v6, v25
  v_dot2_f32_bf16 v22, v117, v7, v22
  v_dot2_f32_bf16 v23, v123, v7, v23
  v_dot2_f32_bf16 v24, v129, v7, v24
  v_dot2_f32_bf16 v25, v135, v7, v25
  v_dot2_f32_bf16 v22, v118, v8, v22
  v_dot2_f32_bf16 v23, v124, v8, v23
  v_dot2_f32_bf16 v24, v130, v8, v24
  v_dot2_f32_bf16 v25, v136, v8, v25
  v_dot2_f32_bf16 v22, v119, v9, v22
  v_dot2_f32_bf16 v23, v125, v9, v23
  v_dot2_f32_bf16 v24, v131, v9, v24
  v_dot2_f32_bf16 v25, v137, v9, v25
  v_add_f32_dpp v26, v22, v22 row_ror:8 row_mask:0xf bank_mask:0x3
  v_add_f32_dpp v27, v23, v23 row_ror:8 row_mask:0xf bank_mask:0x3
  s_nop 0
  v_add_f32_dpp v26, v24, v24 row_ror:8 row_mask:0xf bank_mask:0xc
  v_add_f32_dpp v27, v25, v25 row_ror:8 row_mask:0xf bank_mask:0xc
  s_nop 0
  v_add_f32_dpp v31, v26, v26 row_shl:4 row_mask:0xf bank_mask:0x5
  s_nop 1
  v_add_f32_dpp v31, v27, v27 row_shr:4 row_mask:0xf bank_mask:0xa
  s_nop 1
  v_add_f32_dpp v31, v31, v31 quad_perm:[1,0,3,2] row_mask:0xf bank_mask:0xf
  s_nop 1
  v_add_f32_dpp v31, v31, v31 quad_perm:[2,3,0,1] row_mask:0xf bank_mask:0xf
  v_cvt_pk_bf16_f32 v22, v28, v29
  v_cvt_pk_bf16_f32 v23, v30, v31
  v_lshlrev_b32 v28, 16, v22
  v_and_b32 v29, 0xffff0000, v22
  v_lshlrev_b32 v30, 16, v23
  v_and_b32 v31, 0xffff0000, v23
  v_mul_f32 v28, 0x3d93cd3a, v28
  v_mul_f32 v29, 0x3d93cd3a, v29
  v_mul_f32 v30, 0x3d93cd3a, v30
  v_mul_f32 v31, 0x3d93cd3a, v31
  v_cvt_pk_bf16_f32 v22, v28, v29
  v_cvt_pk_bf16_f32 v23, v30, v31
  v_lshlrev_b32 v28, 16, v22
  v_and_b32 v29, 0xffff0000, v22
  v_lshlrev_b32 v30, 16, v23
  v_and_b32 v31, 0xffff0000, v23
  v_max3_f32 v40, v28, v29, v30
  v_max_f32 v40, v40, v31
  s_nop 1
  v_max_f32_dpp v40, v40, v40 row_ror:4 row_mask:0xf bank_mask:0xf
  s_nop 1
  v_max_f32_dpp v40, v40, v40 row_ror:8 row_mask:0xf bank_mask:0xf
  v_mov_b32 v41, v40
  s_nop 1
  v_permlane16_swap_b32 v40, v41
  v_max_f32 v40, v40, v41
  v_mov_b32 v41, v40
  s_nop 1
  v_permlane32_swap_b32 v40, v41
  v_max_f32 v40, v40, v41
  v_sub_f32 v28, v28, v40
  v_sub_f32 v29, v29, v40
  v_sub_f32 v30, v30, v40
  v_sub_f32 v31, v31, v40
  v_mul_f32 v28, 0x3fb8aa3b, v28
  v_mul_f32 v29, 0x3fb8aa3b, v29
  v_mul_f32 v30, 0x3fb8aa3b, v30
  v_mul_f32 v31, 0x3fb8aa3b, v31
  v_exp_f32 v28, v28
  v_exp_f32 v29, v29
  v_exp_f32 v30, v30
  v_exp_f32 v31, v31
  s_nop 0
  v_cvt_pk_bf16_f32 v32, v28, 0
  v_cvt_pk_bf16_f32 v36, 0, v28
  v_cvt_pk_bf16_f32 v33, v29, 0
  v_cvt_pk_bf16_f32 v37, 0, v29
  v_cvt_pk_bf16_f32 v34, v30, 0
  v_cvt_pk_bf16_f32 v38, 0, v30
  v_cvt_pk_bf16_f32 v35, v31, 0
  v_cvt_pk_bf16_f32 v39, 0, v31
  v_add_f32 v26, v28, v29
  v_add_f32 v27, v30, v31
  v_add_f32 v26, v26, v27
  s_nop 1
  v_add_f32_dpp v26, v26, v26 row_ror:4 row_mask:0xf bank_mask:0xf
  s_nop 1
  v_add_f32_dpp v26, v26, v26 row_ror:8 row_mask:0xf bank_mask:0xf
  v_mov_b32 v41, v26
  s_nop 1
  v_permlane16_swap_b32 v26, v41
  v_add_f32 v26, v26, v41
  v_mov_b32 v41, v26
  s_nop 1
  v_permlane32_swap_b32 v26, v41
  v_add_f32 v26, v26, v41
  s_lshl_b32 s6, s3, 2
  v_mov_b32 v41, s6
  v_mov_b32 v27, 1
  v_mov_b32 v22, 0
  s_mov_b64 exec, 1
  ds_write_b32 v41, v40 offset:400
  ds_write_b32 v41, v26 offset:432
  s_waitcnt lgkmcnt(0)
  ds_add_u32 v22, v27 offset:388
  s_mov_b64 exec, -1
  v_mov_b32 v10, 0
  v_mov_b32 v11, 0
  v_mov_b32 v12, 0
  v_mov_b32 v13, 0
  v_mov_b32 v14, 0
  v_mov_b32 v15, 0
  v_mov_b32 v16, 0
  v_mov_b32 v17, 0
  v_mov_b32 v18, 0
  v_mov_b32 v19, 0
  v_mov_b32 v20, 0
  v_mov_b32 v21, 0
  v_mov_b32 v4, v40
  s_waitcnt vmcnt(4)
  s_mov_b32 s60, 294912
  buffer_load_dwordx4 v[156:159], v1, s[36:39], s60 offen nt
  buffer_load_dwordx2 v[160:161], v2, s[36:39], s60 offen nt
  v_dot2c_f32_bf16_dpp v10, v32, v138 row_newbcast:0 row_mask:0xf bank_mask:0xf
  v_dot2c_f32_bf16_dpp v11, v36, v138 row_newbcast:0 row_mask:0xf bank_mask:0xf
  v_dot2c_f32_bf16_dpp v12, v32, v139 row_newbcast:0 row_mask:0xf bank_mask:0xf
  v_dot2c_f32_bf16_dpp v13, v36, v139 row_newbcast:0 row_mask:0xf bank_mask:0xf
  v_dot2c_f32_bf16_dpp v14, v32, v140 row_newbcast:0 row_mask:0xf bank_mask:0xf
  v_dot2c_f32_bf16_dpp v15, v36, v140 row_newbcast:0 row_mask:0xf bank_mask:0xf
  v_dot2c_f32_bf16_dpp v16, v32, v141 row_newbcast:0 row_mask:0xf bank_mask:0xf
  v_dot2c_f32_bf16_dpp v17, v36, v141 row_newbcast:0 row_mask:0xf bank_mask:0xf
  v_dot2c_f32_bf16_dpp v18, v32, v142 row_newbcast:0 row_mask:0xf bank_mask:0xf
  v_dot2c_f32_bf16_dpp v19, v36, v142 row_newbcast:0 row_mask:0xf bank_mask:0xf
  v_dot2c_f32_bf16_dpp v20, v32, v143 row_newbcast:0 row_mask:0xf bank_mask:0xf
  v_dot2c_f32_bf16_dpp v21, v36, v143 row_newbcast:0 row_mask:0xf bank_mask:0xf
  s_waitcnt vmcnt(4)
  s_mov_b32 s60, 393216
  buffer_load_dwordx4 v[162:165], v1, s[36:39], s60 offen nt
  buffer_load_dwordx2 v[166:167], v2, s[36:39], s60 offen nt
  v_dot2c_f32_bf16_dpp v10, v32, v144 row_newbcast:4 row_mask:0xf bank_mask:0xf
  v_dot2c_f32_bf16_dpp v11, v36, v144 row_newbcast:4 row_mask:0xf bank_mask:0xf
  v_dot2c_f32_bf16_dpp v12, v32, v145 row_newbcast:4 row_mask:0xf bank_mask:0xf
  v_dot2c_f32_bf16_dpp v13, v36, v145 row_newbcast:4 row_mask:0xf bank_mask:0xf
  v_dot2c_f32_bf16_dpp v14, v32, v146 row_newbcast:4 row_mask:0xf bank_mask:0xf
  v_dot2c_f32_bf16_dpp v15, v36, v146 row_newbcast:4 row_mask:0xf bank_mask:0xf
  v_dot2c_f32_bf16_dpp v16, v32, v147 row_newbcast:4 row_mask:0xf bank_mask:0xf
  v_dot2c_f32_bf16_dpp v17, v36, v147 row_newbcast:4 row_mask:0xf bank_mask:0xf
  v_dot2c_f32_bf16_dpp v18, v32, v148 row_newbcast:4 row_mask:0xf bank_mask:0xf
  v_dot2c_f32_bf16_dpp v19, v36, v148 row_newbcast:4 row_mask:0xf bank_mask:0xf
  v_dot2c_f32_bf16_dpp v20, v32, v149 row_newbcast:4 row_mask:0xf bank_mask:0xf
  v_dot2c_f32_bf16_dpp v21, v36, v149 row_newbcast:4 row_mask:0xf bank_mask:0xf
  s_waitcnt vmcnt(4)
  s_mov_b32 s60, 491520
  buffer_load_dwordx4 v[42:45], v1, s[36:39], s60 offen nt
  buffer_load_dwordx2 v[46:47], v2, s[36:39], s60 offen nt
  v_dot2c_f32_bf16_dpp v10, v32, v150 row_newbcast:8 row_mask:0xf bank_mask:0xf
  v_dot2c_f32_bf16_dpp v11, v36, v150 row_newbcast:8 row_mask:0xf bank_mask:0xf
  v_dot2c_f32_bf16_dpp v12, v32, v151 row_newbcast:8 row_mask:0xf bank_mask:0xf
  v_dot2c_f32_bf16_dpp v13, v36, v151 row_newbcast:8 row_mask:0xf bank_mask:0xf
  v_dot2c_f32_bf16_dpp v14, v32, v152 row_newbcast:8 row_mask:0xf bank_mask:0xf
  v_dot2c_f32_bf16_dpp v15, v36, v152 row_newbcast:8 row_mask:0xf bank_mask:0xf
  v_dot2c_f32_bf16_dpp v16, v32, v153 row_newbcast:8 row_mask:0xf bank_mask:0xf
  v_dot2c_f32_bf16_dpp v17, v36, v153 row_newbcast:8 row_mask:0xf bank_mask:0xf
  v_dot2c_f32_bf16_dpp v18, v32, v154 row_newbcast:8 row_mask:0xf bank_mask:0xf
  v_dot2c_f32_bf16_dpp v19, v36, v154 row_newbcast:8 row_mask:0xf bank_mask:0xf
  v_dot2c_f32_bf16_dpp v20, v32, v155 row_newbcast:8 row_mask:0xf bank_mask:0xf
  v_dot2c_f32_bf16_dpp v21, v36, v155 row_newbcast:8 row_mask:0xf bank_mask:0xf
  s_waitcnt vmcnt(4)
  s_mov_b32 s60, 589824
  buffer_load_dwordx4 v[48:51], v1, s[36:39], s60 offen nt
  buffer_load_dwordx2 v[52:53], v2, s[36:39], s60 offen nt
  v_dot2c_f32_bf16_dpp v10, v32, v156 row_newbcast:12 row_mask:0xf bank_mask:0xf
  v_dot2c_f32_bf16_dpp v11, v36, v156 row_newbcast:12 row_mask:0xf bank_mask:0xf
  v_dot2c_f32_bf16_dpp v12, v32, v157 row_newbcast:12 row_mask:0xf bank_mask:0xf
  v_dot2c_f32_bf16_dpp v13, v36, v157 row_newbcast:12 row_mask:0xf bank_mask:0xf
  v_dot2c_f32_bf16_dpp v14, v32, v158 row_newbcast:12 row_mask:0xf bank_mask:0xf
  v_dot2c_f32_bf16_dpp v15, v36, v158 row_newbcast:12 row_mask:0xf bank_mask:0xf
  v_dot2c_f32_bf16_dpp v16, v32, v159 row_newbcast:12 row_mask:0xf bank_mask:0xf
  v_dot2c_f32_bf16_dpp v17, v36, v159 row_newbcast:12 row_mask:0xf bank_mask:0xf
  v_dot2c_f32_bf16_dpp v18, v32, v160 row_newbcast:12 row_mask:0xf bank_mask:0xf
  v_dot2c_f32_bf16_dpp v19, v36, v160 row_newbcast:12 row_mask:0xf bank_mask:0xf
  v_dot2c_f32_bf16_dpp v20, v32, v161 row_newbcast:12 row_mask:0xf bank_mask:0xf
  v_dot2c_f32_bf16_dpp v21, v36, v161 row_newbcast:12 row_mask:0xf bank_mask:0xf
  s_waitcnt vmcnt(4)
  s_mov_b32 s60, 688128
  buffer_load_dwordx4 v[54:57], v1, s[36:39], s60 offen nt
  buffer_load_dwordx2 v[58:59], v2, s[36:39], s60 offen nt
  v_dot2c_f32_bf16_dpp v10, v33, v162 row_newbcast:0 row_mask:0xf bank_mask:0xf
  v_dot2c_f32_bf16_dpp v11, v37, v162 row_newbcast:0 row_mask:0xf bank_mask:0xf
  v_dot2c_f32_bf16_dpp v12, v33, v163 row_newbcast:0 row_mask:0xf bank_mask:0xf
  v_dot2c_f32_bf16_dpp v13, v37, v163 row_newbcast:0 row_mask:0xf bank_mask:0xf
  v_dot2c_f32_bf16_dpp v14, v33, v164 row_newbcast:0 row_mask:0xf bank_mask:0xf
  v_dot2c_f32_bf16_dpp v15, v37, v164 row_newbcast:0 row_mask:0xf bank_mask:0xf
  v_dot2c_f32_bf16_dpp v16, v33, v165 row_newbcast:0 row_mask:0xf bank_mask:0xf
  v_dot2c_f32_bf16_dpp v17, v37, v165 row_newbcast:0 row_mask:0xf bank_mask:0xf
  v_dot2c_f32_bf16_dpp v18, v33, v166 row_newbcast:0 row_mask:0xf bank_mask:0xf
  v_dot2c_f32_bf16_dpp v19, v37, v166 row_newbcast:0 row_mask:0xf bank_mask:0xf
  v_dot2c_f32_bf16_dpp v20, v33, v167 row_newbcast:0 row_mask:0xf bank_mask:0xf
  v_dot2c_f32_bf16_dpp v21, v37, v167 row_newbcast:0 row_mask:0xf bank_mask:0xf
  s_waitcnt vmcnt(4)
  s_mov_b32 s60, 786432
  buffer_load_dwordx4 v[60:63], v1, s[36:39], s60 offen nt
  buffer_load_dwordx2 v[64:65], v2, s[36:39], s60 offen nt
  v_dot2c_f32_bf16_dpp v10, v33, v42 row_newbcast:4 row_mask:0xf bank_mask:0xf
  v_dot2c_f32_bf16_dpp v11, v37, v42 row_newbcast:4 row_mask:0xf bank_mask:0xf
  v_dot2c_f32_bf16_dpp v12, v33, v43 row_newbcast:4 row_mask:0xf bank_mask:0xf
  v_dot2c_f32_bf16_dpp v13, v37, v43 row_newbcast:4 row_mask:0xf bank_mask:0xf
  v_dot2c_f32_bf16_dpp v14, v33, v44 row_newbcast:4 row_mask:0xf bank_mask:0xf
  v_dot2c_f32_bf16_dpp v15, v37, v44 row_newbcast:4 row_mask:0xf bank_mask:0xf
  v_dot2c_f32_bf16_dpp v16, v33, v45 row_newbcast:4 row_mask:0xf bank_mask:0xf
  v_dot2c_f32_bf16_dpp v17, v37, v45 row_newbcast:4 row_mask:0xf bank_mask:0xf
  v_dot2c_f32_bf16_dpp v18, v33, v46 row_newbcast:4 row_mask:0xf bank_mask:0xf
  v_dot2c_f32_bf16_dpp v19, v37, v46 row_newbcast:4 row_mask:0xf bank_mask:0xf
  v_dot2c_f32_bf16_dpp v20, v33, v47 row_newbcast:4 row_mask:0xf bank_mask:0xf
  v_dot2c_f32_bf16_dpp v21, v37, v47 row_newbcast:4 row_mask:0xf bank_mask:0xf
  s_waitcnt vmcnt(4)
  v_mov_b32 v8, 0
  s_mov_b32 s57, 0
L_frdy_3:
  ds_read_b32 v9, v8 offset:484
  s_waitcnt lgkmcnt(0)
  v_readfirstlane_b32 s58, v9
  s_add_u32 s57, s57, 1
  s_cmp_gt_u32 s57, 240000
  s_cbranch_scc1 L_frdyd_4
  s_cmp_lg_u32 s58, 0
  s_cbranch_scc1 L_frdyd_4
  s_sleep 1
  s_branch L_frdy_3
L_frdyd_4:
  s_mov_b32 s60, 884736
  buffer_load_dwordx4 v[66:69], v1, s[36:39], s60 offen nt
  buffer_load_dwordx2 v[70:71], v2, s[36:39], s60 offen nt
  v_mov_b32 v41, 0
  v_mov_b32 v40, 1
  s_mov_b64 exec, 1
  ds_add_u32 v41, v40 offset:488
  s_mov_b64 exec, -1
  v_dot2c_f32_bf16_dpp v10, v33, v48 row_newbcast:8 row_mask:0xf bank_mask:0xf
  v_dot2c_f32_bf16_dpp v11, v37, v48 row_newbcast:8 row_mask:0xf bank_mask:0xf
  v_dot2c_f32_bf16_dpp v12, v33, v49 row_newbcast:8 row_mask:0xf bank_mask:0xf
  v_dot2c_f32_bf16_dpp v13, v37, v49 row_newbcast:8 row_mask:0xf bank_mask:0xf
  v_dot2c_f32_bf16_dpp v14, v33, v50 row_newbcast:8 row_mask:0xf bank_mask:0xf
  v_dot2c_f32_bf16_dpp v15, v37, v50 row_newbcast:8 row_mask:0xf bank_mask:0xf
  v_dot2c_f32_bf16_dpp v16, v33, v51 row_newbcast:8 row_mask:0xf bank_mask:0xf
  v_dot2c_f32_bf16_dpp v17, v37, v51 row_newbcast:8 row_mask:0xf bank_mask:0xf
  v_dot2c_f32_bf16_dpp v18, v33, v52 row_newbcast:8 row_mask:0xf bank_mask:0xf
  v_dot2c_f32_bf16_dpp v19, v37, v52 row_newbcast:8 row_mask:0xf bank_mask:0xf
  v_dot2c_f32_bf16_dpp v20, v33, v53 row_newbcast:8 row_mask:0xf bank_mask:0xf
  v_dot2c_f32_bf16_dpp v21, v37, v53 row_newbcast:8 row_mask:0xf bank_mask:0xf
  s_waitcnt vmcnt(4)
  s_mov_b32 s60, 983040
  buffer_load_dwordx4 v[72:75], v1, s[36:39], s60 offen nt
  buffer_load_dwordx2 v[76:77], v2, s[36:39], s60 offen nt
  v_dot2c_f32_bf16_dpp v10, v33, v54 row_newbcast:12 row_mask:0xf bank_mask:0xf
  v_dot2c_f32_bf16_dpp v11, v37, v54 row_newbcast:12 row_mask:0xf bank_mask:0xf
  v_dot2c_f32_bf16_dpp v12, v33, v55 row_newbcast:12 row_mask:0xf bank_mask:0xf
  v_dot2c_f32_bf16_dpp v13, v37, v55 row_newbcast:12 row_mask:0xf bank_mask:0xf
  v_dot2c_f32_bf16_dpp v14, v33, v56 row_newbcast:12 row_mask:0xf bank_mask:0xf
  v_dot2c_f32_bf16_dpp v15, v37, v56 row_newbcast:12 row_mask:0xf bank_mask:0xf
  v_dot2c_f32_bf16_dpp v16, v33, v57 row_newbcast:12 row_mask:0xf bank_mask:0xf
  v_dot2c_f32_bf16_dpp v17, v37, v57 row_newbcast:12 row_mask:0xf bank_mask:0xf
  v_dot2c_f32_bf16_dpp v18, v33, v58 row_newbcast:12 row_mask:0xf bank_mask:0xf
  v_dot2c_f32_bf16_dpp v19, v37, v58 row_newbcast:12 row_mask:0xf bank_mask:0xf
  v_dot2c_f32_bf16_dpp v20, v33, v59 row_newbcast:12 row_mask:0xf bank_mask:0xf
  v_dot2c_f32_bf16_dpp v21, v37, v59 row_newbcast:12 row_mask:0xf bank_mask:0xf
  s_waitcnt vmcnt(4)
  s_mov_b32 s60, 1081344
  buffer_load_dwordx4 v[78:81], v1, s[36:39], s60 offen nt
  buffer_load_dwordx2 v[82:83], v2, s[36:39], s60 offen nt
  v_dot2c_f32_bf16_dpp v10, v34, v60 row_newbcast:0 row_mask:0xf bank_mask:0xf
  v_dot2c_f32_bf16_dpp v11, v38, v60 row_newbcast:0 row_mask:0xf bank_mask:0xf
  v_dot2c_f32_bf16_dpp v12, v34, v61 row_newbcast:0 row_mask:0xf bank_mask:0xf
  v_dot2c_f32_bf16_dpp v13, v38, v61 row_newbcast:0 row_mask:0xf bank_mask:0xf
  v_dot2c_f32_bf16_dpp v14, v34, v62 row_newbcast:0 row_mask:0xf bank_mask:0xf
  v_dot2c_f32_bf16_dpp v15, v38, v62 row_newbcast:0 row_mask:0xf bank_mask:0xf
  v_dot2c_f32_bf16_dpp v16, v34, v63 row_newbcast:0 row_mask:0xf bank_mask:0xf
  v_dot2c_f32_bf16_dpp v17, v38, v63 row_newbcast:0 row_mask:0xf bank_mask:0xf
  v_dot2c_f32_bf16_dpp v18, v34, v64 row_newbcast:0 row_mask:0xf bank_mask:0xf
  v_dot2c_f32_bf16_dpp v19, v38, v64 row_newbcast:0 row_mask:0xf bank_mask:0xf
  v_dot2c_f32_bf16_dpp v20, v34, v65 row_newbcast:0 row_mask:0xf bank_mask:0xf
  v_dot2c_f32_bf16_dpp v21, v38, v65 row_newbcast:0 row_mask:0xf bank_mask:0xf
  s_waitcnt vmcnt(4)
  s_mov_b32 s60, 1179648
  buffer_load_dwordx4 v[84:87], v1, s[36:39], s60 offen nt
  buffer_load_dwordx2 v[88:89], v2, s[36:39], s60 offen nt
  v_dot2c_f32_bf16_dpp v10, v34, v66 row_newbcast:4 row_mask:0xf bank_mask:0xf
  v_dot2c_f32_bf16_dpp v11, v38, v66 row_newbcast:4 row_mask:0xf bank_mask:0xf
  v_dot2c_f32_bf16_dpp v12, v34, v67 row_newbcast:4 row_mask:0xf bank_mask:0xf
  v_dot2c_f32_bf16_dpp v13, v38, v67 row_newbcast:4 row_mask:0xf bank_mask:0xf
  v_dot2c_f32_bf16_dpp v14, v34, v68 row_newbcast:4 row_mask:0xf bank_mask:0xf
  v_dot2c_f32_bf16_dpp v15, v38, v68 row_newbcast:4 row_mask:0xf bank_mask:0xf
  v_dot2c_f32_bf16_dpp v16, v34, v69 row_newbcast:4 row_mask:0xf bank_mask:0xf
  v_dot2c_f32_bf16_dpp v17, v38, v69 row_newbcast:4 row_mask:0xf bank_mask:0xf
  v_dot2c_f32_bf16_dpp v18, v34, v70 row_newbcast:4 row_mask:0xf bank_mask:0xf
  v_dot2c_f32_bf16_dpp v19, v38, v70 row_newbcast:4 row_mask:0xf bank_mask:0xf
  v_dot2c_f32_bf16_dpp v20, v34, v71 row_newbcast:4 row_mask:0xf bank_mask:0xf
  v_dot2c_f32_bf16_dpp v21, v38, v71 row_newbcast:4 row_mask:0xf bank_mask:0xf
  s_waitcnt vmcnt(4)
  s_mov_b32 s60, 1277952
  buffer_load_dwordx4 v[90:93], v1, s[36:39], s60 offen nt
  buffer_load_dwordx2 v[94:95], v2, s[36:39], s60 offen nt
  v_dot2c_f32_bf16_dpp v10, v34, v72 row_newbcast:8 row_mask:0xf bank_mask:0xf
  v_dot2c_f32_bf16_dpp v11, v38, v72 row_newbcast:8 row_mask:0xf bank_mask:0xf
  v_dot2c_f32_bf16_dpp v12, v34, v73 row_newbcast:8 row_mask:0xf bank_mask:0xf
  v_dot2c_f32_bf16_dpp v13, v38, v73 row_newbcast:8 row_mask:0xf bank_mask:0xf
  v_dot2c_f32_bf16_dpp v14, v34, v74 row_newbcast:8 row_mask:0xf bank_mask:0xf
  v_dot2c_f32_bf16_dpp v15, v38, v74 row_newbcast:8 row_mask:0xf bank_mask:0xf
  v_dot2c_f32_bf16_dpp v16, v34, v75 row_newbcast:8 row_mask:0xf bank_mask:0xf
  v_dot2c_f32_bf16_dpp v17, v38, v75 row_newbcast:8 row_mask:0xf bank_mask:0xf
  v_dot2c_f32_bf16_dpp v18, v34, v76 row_newbcast:8 row_mask:0xf bank_mask:0xf
  v_dot2c_f32_bf16_dpp v19, v38, v76 row_newbcast:8 row_mask:0xf bank_mask:0xf
  v_dot2c_f32_bf16_dpp v20, v34, v77 row_newbcast:8 row_mask:0xf bank_mask:0xf
  v_dot2c_f32_bf16_dpp v21, v38, v77 row_newbcast:8 row_mask:0xf bank_mask:0xf
  s_waitcnt vmcnt(4)
  s_mov_b32 s60, 1376256
  buffer_load_dwordx4 v[96:99], v1, s[36:39], s60 offen nt
  buffer_load_dwordx2 v[100:101], v2, s[36:39], s60 offen nt
  v_dot2c_f32_bf16_dpp v10, v34, v78 row_newbcast:12 row_mask:0xf bank_mask:0xf
  v_dot2c_f32_bf16_dpp v11, v38, v78 row_newbcast:12 row_mask:0xf bank_mask:0xf
  v_dot2c_f32_bf16_dpp v12, v34, v79 row_newbcast:12 row_mask:0xf bank_mask:0xf
  v_dot2c_f32_bf16_dpp v13, v38, v79 row_newbcast:12 row_mask:0xf bank_mask:0xf
  v_dot2c_f32_bf16_dpp v14, v34, v80 row_newbcast:12 row_mask:0xf bank_mask:0xf
  v_dot2c_f32_bf16_dpp v15, v38, v80 row_newbcast:12 row_mask:0xf bank_mask:0xf
  v_dot2c_f32_bf16_dpp v16, v34, v81 row_newbcast:12 row_mask:0xf bank_mask:0xf
  v_dot2c_f32_bf16_dpp v17, v38, v81 row_newbcast:12 row_mask:0xf bank_mask:0xf
  v_dot2c_f32_bf16_dpp v18, v34, v82 row_newbcast:12 row_mask:0xf bank_mask:0xf
  v_dot2c_f32_bf16_dpp v19, v38, v82 row_newbcast:12 row_mask:0xf bank_mask:0xf
  v_dot2c_f32_bf16_dpp v20, v34, v83 row_newbcast:12 row_mask:0xf bank_mask:0xf
  v_dot2c_f32_bf16_dpp v21, v38, v83 row_newbcast:12 row_mask:0xf bank_mask:0xf
  s_waitcnt vmcnt(4)
  s_mov_b32 s60, 1474560
  buffer_load_dwordx4 v[102:105], v1, s[36:39], s60 offen nt
  buffer_load_dwordx2 v[106:107], v2, s[36:39], s60 offen nt
  v_mov_b32 v8, 0
  v_mov_b32 v9, 1
  s_mov_b64 exec, 1
  ds_add_u32 v8, v9 offset:472
  s_mov_b64 exec, -1
  v_dot2c_f32_bf16_dpp v10, v35, v84 row_newbcast:0 row_mask:0xf bank_mask:0xf
  v_dot2c_f32_bf16_dpp v11, v39, v84 row_newbcast:0 row_mask:0xf bank_mask:0xf
  v_dot2c_f32_bf16_dpp v12, v35, v85 row_newbcast:0 row_mask:0xf bank_mask:0xf
  v_dot2c_f32_bf16_dpp v13, v39, v85 row_newbcast:0 row_mask:0xf bank_mask:0xf
  v_dot2c_f32_bf16_dpp v14, v35, v86 row_newbcast:0 row_mask:0xf bank_mask:0xf
  v_dot2c_f32_bf16_dpp v15, v39, v86 row_newbcast:0 row_mask:0xf bank_mask:0xf
  v_dot2c_f32_bf16_dpp v16, v35, v87 row_newbcast:0 row_mask:0xf bank_mask:0xf
  v_dot2c_f32_bf16_dpp v17, v39, v87 row_newbcast:0 row_mask:0xf bank_mask:0xf
  v_dot2c_f32_bf16_dpp v18, v35, v88 row_newbcast:0 row_mask:0xf bank_mask:0xf
  v_dot2c_f32_bf16_dpp v19, v39, v88 row_newbcast:0 row_mask:0xf bank_mask:0xf
  v_dot2c_f32_bf16_dpp v20, v35, v89 row_newbcast:0 row_mask:0xf bank_mask:0xf
  v_dot2c_f32_bf16_dpp v21, v39, v89 row_newbcast:0 row_mask:0xf bank_mask:0xf
  v_mov_b32 v41, 0
  s_mov_b32 s57, 0
L_cnt8_5:
  ds_read_b32 v40, v41 offset:388
  s_waitcnt lgkmcnt(0)
  v_readfirstlane_b32 s58, v40
  s_add_u32 s57, s57, 1
  s_cmp_gt_u32 s57, 240000
  s_cbranch_scc1 L_cnt8d_6
  s_cmp_eq_u32 s58, 8
  s_cbranch_scc1 L_cnt8d_6
  s_sleep 1
  s_branch L_cnt8_5
L_cnt8d_6:
  v_and_b32 v41, 7, v0
  v_lshlrev_b32 v41, 2, v41
  ds_read_b32 v40, v41 offset:400
  v_and_b32 v22, 15, v0
  v_lshrrev_b32 v23, 4, v0
  v_lshlrev_b32 v23, 2, v23
  s_mul_i32 s6, s3, 768
  v_add_u32 v23, s6, v23
  v_lshl_add_u32 v6, v22, 5, v23
  v_lshl_add_u32 v7, v22, 4, v23
  s_waitcnt lgkmcnt(0)
  v_max_f32_dpp v40, v40, v40 row_ror:1 row_mask:0xf bank_mask:0xf
  s_nop 1
  v_max_f32_dpp v40, v40, v40 row_ror:2 row_mask:0xf bank_mask:0xf
  s_nop 1
  v_max_f32_dpp v40, v40, v40 row_ror:4 row_mask:0xf bank_mask:0xf
  v_sub_f32 v5, v4, v40
  v_mul_f32 v5, 0x3fb8aa3b, v5
  v_exp_f32 v5, v5
  s_waitcnt vmcnt(4)
  v_dot2c_f32_bf16_dpp v10, v35, v90 row_newbcast:4 row_mask:0xf bank_mask:0xf
  v_dot2c_f32_bf16_dpp v11, v39, v90 row_newbcast:4 row_mask:0xf bank_mask:0xf
  v_dot2c_f32_bf16_dpp v12, v35, v91 row_newbcast:4 row_mask:0xf bank_mask:0xf
  v_dot2c_f32_bf16_dpp v13, v39, v91 row_newbcast:4 row_mask:0xf bank_mask:0xf
  v_dot2c_f32_bf16_dpp v14, v35, v92 row_newbcast:4 row_mask:0xf bank_mask:0xf
  v_dot2c_f32_bf16_dpp v15, v39, v92 row_newbcast:4 row_mask:0xf bank_mask:0xf
  v_dot2c_f32_bf16_dpp v16, v35, v93 row_newbcast:4 row_mask:0xf bank_mask:0xf
  v_dot2c_f32_bf16_dpp v17, v39, v93 row_newbcast:4 row_mask:0xf bank_mask:0xf
  v_dot2c_f32_bf16_dpp v18, v35, v94 row_newbcast:4 row_mask:0xf bank_mask:0xf
  v_dot2c_f32_bf16_dpp v19, v39, v94 row_newbcast:4 row_mask:0xf bank_mask:0xf
  v_dot2c_f32_bf16_dpp v20, v35, v95 row_newbcast:4 row_mask:0xf bank_mask:0xf
  v_dot2c_f32_bf16_dpp v21, v39, v95 row_newbcast:4 row_mask:0xf bank_mask:0xf
  s_waitcnt vmcnt(2)
  v_dot2c_f32_bf16_dpp v10, v35, v96 row_newbcast:8 row_mask:0xf bank_mask:0xf
  v_dot2c_f32_bf16_dpp v11, v39, v96 row_newbcast:8 row_mask:0xf bank_mask:0xf
  v_dot2c_f32_bf16_dpp v12, v35, v97 row_newbcast:8 row_mask:0xf bank_mask:0xf
  v_dot2c_f32_bf16_dpp v13, v39, v97 row_newbcast:8 row_mask:0xf bank_mask:0xf
  v_dot2c_f32_bf16_dpp v14, v35, v98 row_newbcast:8 row_mask:0xf bank_mask:0xf
  v_dot2c_f32_bf16_dpp v15, v39, v98 row_newbcast:8 row_mask:0xf bank_mask:0xf
  v_dot2c_f32_bf16_dpp v16, v35, v99 row_newbcast:8 row_mask:0xf bank_mask:0xf
  v_dot2c_f32_bf16_dpp v17, v39, v99 row_newbcast:8 row_mask:0xf bank_mask:0xf
  v_dot2c_f32_bf16_dpp v18, v35, v100 row_newbcast:8 row_mask:0xf bank_mask:0xf
  v_dot2c_f32_bf16_dpp v19, v39, v100 row_newbcast:8 row_mask:0xf bank_mask:0xf
  v_dot2c_f32_bf16_dpp v20, v35, v101 row_newbcast:8 row_mask:0xf bank_mask:0xf
  v_dot2c_f32_bf16_dpp v21, v39, v101 row_newbcast:8 row_mask:0xf bank_mask:0xf
  s_waitcnt vmcnt(0)
  v_dot2c_f32_bf16_dpp v10, v35, v102 row_newbcast:12 row_mask:0xf bank_mask:0xf
  v_dot2c_f32_bf16_dpp v11, v39, v102 row_newbcast:12 row_mask:0xf bank_mask:0xf
  v_dot2c_f32_bf16_dpp v12, v35, v103 row_newbcast:12 row_mask:0xf bank_mask:0xf
  v_dot2c_f32_bf16_dpp v13, v39, v103 row_newbcast:12 row_mask:0xf bank_mask:0xf
  v_dot2c_f32_bf16_dpp v14, v35, v104 row_newbcast:12 row_mask:0xf bank_mask:0xf
  v_dot2c_f32_bf16_dpp v15, v39, v104 row_newbcast:12 row_mask:0xf bank_mask:0xf
  v_dot2c_f32_bf16_dpp v16, v35, v105 row_newbcast:12 row_mask:0xf bank_mask:0xf
  v_dot2c_f32_bf16_dpp v17, v39, v105 row_newbcast:12 row_mask:0xf bank_mask:0xf
  v_dot2c_f32_bf16_dpp v18, v35, v106 row_newbcast:12 row_mask:0xf bank_mask:0xf
  v_dot2c_f32_bf16_dpp v19, v39, v106 row_newbcast:12 row_mask:0xf bank_mask:0xf
  v_dot2c_f32_bf16_dpp v20, v35, v107 row_newbcast:12 row_mask:0xf bank_mask:0xf
  v_dot2c_f32_bf16_dpp v21, v39, v107 row_newbcast:12 row_mask:0xf bank_mask:0xf
  v_permlane32_swap_b32 v10, v12
  v_permlane32_swap_b32 v11, v13
  v_permlane32_swap_b32 v14, v16
  v_permlane32_swap_b32 v15, v17
  v_permlane32_swap_b32 v18, v20
  v_permlane32_swap_b32 v19, v21
  v_add_f32 v10, v10, v12
  v_add_f32 v11, v11, v13
  v_add_f32 v14, v14, v16
  v_add_f32 v15, v15, v17
  v_add_f32 v18, v18, v20
  v_add_f32 v19, v19, v21
  v_permlane16_swap_b32 v10, v11
  v_permlane16_swap_b32 v14, v15
  v_permlane16_swap_b32 v18, v19
  v_add_f32 v10, v10, v11
  v_add_f32 v14, v14, v15
  v_add_f32 v18, v18, v19
  v_mul_f32 v10, v5, v10
  v_mul_f32 v14, v5, v14
  v_mul_f32 v18, v5, v18
  ds_write_b32 v6, v10 offset:36864
  ds_write_b32 v6, v14 offset:36880
  ds_write_b32 v7, v18 offset:37376
  s_mov_b64 exec, 1
  ds_add_u32 v8, v9 offset:480
  s_mov_b64 exec, -1
  v_lshrrev_b32 v22, 4, v0
  v_bfe_u32 v24, v0, 2, 2
  v_and_b32 v25, 3, v0
  v_lshl_add_u32 v94, v22, 3, v24
  v_lshlrev_b32 v94, 7, v94
  s_and_b32 s6, s3, 3
  s_lshl_b32 s7, s6, 1
  v_lshrrev_b32 v95, 1, v25
  v_add_u32 v95, s7, v95
  v_lshlrev_b32 v96, 1, v24
  v_xor_b32 v95, v95, v96
  v_lshl_add_u32 v94, v95, 4, v94
  v_and_b32 v95, 1, v25
  v_lshl_add_u32 v94, v95, 3, v94
  v_and_b32 v95, 7, v0
  v_mul_u32_u24 v95, 400, v95
  v_lshl_add_u32 v95, v22, 4, v95
  v_lshlrev_b32 v96, 2, v0
  v_mov_b32 v90, 0
  v_mov_b32 v91, 0
  v_mov_b32 v92, 0
  v_mov_b32 v93, 0
  s_mov_b32 s44, s30
  s_mov_b32 s45, s31
  s_mov_b32 s46, 2097152
  s_mov_b32 s47, 0x20000
  s_waitcnt lgkmcnt(0)
  s_cmp_ge_u32 s3, 4
  s_cbranch_scc1 L_tail_extra
  s_lshl_b32 s7, s5, 2
  s_add_u32 s6, s6, s7
  s_mul_i32 s6, s6, 8448
  s_lshl_b32 s7, s4, 6
  s_add_u32 s6, s6, s7
  s_add_u32 s6, s6, 524288
  v_mov_b32 v41, 0
  s_mov_b32 s57, 0
L_wok_7:
  ds_read_b32 v40, v41 offset:476
  s_waitcnt lgkmcnt(0)
  v_readfirstlane_b32 s58, v40
  s_add_u32 s57, s57, 1
  s_cmp_gt_u32 s57, 240000
  s_cbranch_scc1 L_wokd_8
  s_cmp_lg_u32 s58, 0
  s_cbranch_scc1 L_wokd_8
  s_sleep 1
  s_branch L_wok_7
L_wokd_8:
  ds_read_b64_tr_b16 v[42:43], v94 offset:4096
  ds_read_b64_tr_b16 v[44:45], v94 offset:4608
  ds_read_b64_tr_b16 v[46:47], v94 offset:8192
  ds_read_b64_tr_b16 v[48:49], v94 offset:8704
  ds_read_b64_tr_b16 v[50:51], v94 offset:12288
  ds_read_b64_tr_b16 v[52:53], v94 offset:12800
  ds_read_b64_tr_b16 v[54:55], v94 offset:16384
  ds_read_b64_tr_b16 v[56:57], v94 offset:16896
  ds_read_b64_tr_b16 v[58:59], v94 offset:20480
  ds_read_b64_tr_b16 v[60:61], v94 offset:20992
  ds_read_b64_tr_b16 v[62:63], v94 offset:24576
  ds_read_b64_tr_b16 v[64:65], v94 offset:25088
  v_add_u32 v96, s6, v96
  s_waitcnt lgkmcnt(0)
  s_barrier
  ds_read_b128 v[66:69], v95 offset:43008
  ds_read_b128 v[70:73], v95 offset:43072
  ds_read_b128 v[74:77], v95 offset:43136
  ds_read_b128 v[78:81], v95 offset:43200
  ds_read_b128 v[82:85], v95 offset:43264
  ds_read_b128 v[86:89], v95 offset:43328
  s_waitcnt lgkmcnt(5)
  v_mfma_f32_16x16x32_bf16 v[90:93], v[66:69], v[42:45], v[90:93]
  s_waitcnt lgkmcnt(4)
  v_mfma_f32_16x16x32_bf16 v[90:93], v[70:73], v[46:49], v[90:93]
  s_waitcnt lgkmcnt(3)
  v_mfma_f32_16x16x32_bf16 v[90:93], v[74:77], v[50:53], v[90:93]
  s_waitcnt lgkmcnt(2)
  v_mfma_f32_16x16x32_bf16 v[90:93], v[78:81], v[54:57], v[90:93]
  s_waitcnt lgkmcnt(1)
  v_mfma_f32_16x16x32_bf16 v[90:93], v[82:85], v[58:61], v[90:93]
  s_waitcnt lgkmcnt(0)
  v_mfma_f32_16x16x32_bf16 v[90:93], v[86:89], v[62:65], v[90:93]
  s_nop 7
  v_add_f32 v90, v90, v91
  v_add_f32 v92, v92, v93
  v_add_f32 v90, v90, v92
  v_mov_b32 v40, v90
  s_nop 1
  v_permlane16_swap_b32 v90, v40
  v_add_f32 v90, v90, v40
  v_min_u32 v90, -2, v90
  s_mov_b32 exec_lo, 0xffff
  s_mov_b32 exec_hi, 0
  buffer_store_dword v90, v96, s[44:47], 0 offen sc1
  s_mov_b64 exec, -1
  s_branch L_exit_stamped
L_tail_extra:
  s_cmp_ge_u32 s5, 6
  s_cbranch_scc1 L_exit_stamped
  s_cmp_ge_u32 s5, 3
  s_cselect_b32 s7, 4, 0
  s_cselect_b32 s56, 3, 0
  s_sub_u32 s56, s5, s56
  s_add_u32 s6, s6, s7
  s_add_u32 s6, s6, 32
  s_mul_i32 s6, s6, 8448
  s_mul_i32 s7, s4, 3
  s_add_u32 s7, s7, s56
  s_lshl_b32 s7, s7, 6
  s_add_u32 s6, s6, s7
  s_add_u32 s6, s6, 524288
  s_lshl_b32 s7, s56, 7
  v_add_u32 v95, s7, v95
  v_mov_b32 v41, 0
  s_mov_b32 s57, 0
L_wok_9:
  ds_read_b32 v40, v41 offset:476
  s_waitcnt lgkmcnt(0)
  v_readfirstlane_b32 s58, v40
  s_add_u32 s57, s57, 1
  s_cmp_gt_u32 s57, 240000
  s_cbranch_scc1 L_wokd_10
  s_cmp_lg_u32 s58, 0
  s_cbranch_scc1 L_wokd_10
  s_sleep 1
  s_branch L_wok_9
L_wokd_10:
  ds_read_b64_tr_b16 v[42:43], v94 offset:28672
  ds_read_b64_tr_b16 v[44:45], v94 offset:29184
  ds_read_b64_tr_b16 v[46:47], v94 offset:32768
  ds_read_b64_tr_b16 v[48:49], v94 offset:33280
  v_add_u32 v96, s6, v96
  s_waitcnt lgkmcnt(0)
  s_barrier
  ds_read_b128 v[66:69], v95 offset:43008
  ds_read_b128 v[70:73], v95 offset:43072
  s_waitcnt lgkmcnt(1)
  v_mfma_f32_16x16x32_bf16 v[90:93], v[66:69], v[42:45], v[90:93]
  s_waitcnt lgkmcnt(0)
  v_mfma_f32_16x16x32_bf16 v[90:93], v[70:73], v[46:49], v[90:93]
  s_nop 7
  v_add_f32 v90, v90, v91
  v_add_f32 v92, v92, v93
  v_add_f32 v90, v90, v92
  v_mov_b32 v40, v90
  s_nop 1
  v_permlane16_swap_b32 v90, v40
  v_add_f32 v90, v90, v40
  v_min_u32 v90, -2, v90
  s_mov_b32 exec_lo, 0xffff
  s_mov_b32 exec_hi, 0
  buffer_store_dword v90, v96, s[44:47], 0 offen sc1
  s_mov_b64 exec, -1
  s_branch L_exit_stamped
L_helper:
  s_setprio 3
  s_sub_u32 s7, s3, 8
  v_lshlrev_b32 v1, 2, v0
  s_mov_b32 s60, 2560
  s_mov_b32 s61, 5120
  s_mov_b32 s62, 7680
  s_cmp_eq_u32 s3, 11
  s_cbranch_scc1 L_h3
  s_waitcnt lgkmcnt(0)
  s_mov_b32 s32, s8
  s_mov_b32 s33, s9
  s_mov_b32 s34, 1280
  s_mov_b32 s35, 0x20000
  s_mov_b32 s44, s30
  s_mov_b32 s45, s31
  s_mov_b32 s46, 2097152
  s_mov_b32 s47, 0x20000
  s_mov_b32 s48, s28
  s_mov_b32 s49, s29
  s_mov_b32 s50, 256
  s_mov_b32 s51, 0x20000
  s_mul_i32 s6, s5, 983040
  s_mul_i32 s56, s4, 384
  s_add_u32 s6, s6, s56
  s_add_u32 s36, s14, s6
  s_addc_u32 s37, s15, 0
  s_mov_b32 s38, 971136
  s_mov_b32 s39, 0x20000
  v_lshrrev_b32 v2, 3, v0
  v_mul_u32_u24 v2, 12288, v2
  v_and_b32 v3, 7, v0
  v_lshl_add_u32 v2, v3, 4, v2
  s_lshl_b32 s6, s7, 7
  v_add_u32 v2, s6, v2
  buffer_load_dword v4, v1, s[32:35], 0 offen
  buffer_load_dword v5, v1, s[32:35], 0 offen offset:256
  buffer_load_dword v6, v1, s[32:35], 0 offen offset:512
  buffer_load_dword v7, v1, s[32:35], 0 offen offset:768
  buffer_load_dword v8, v1, s[32:35], 0 offen offset:1024
  s_mov_b32 s6, 0
  buffer_load_dwordx4 v[64:67], v2, s[36:39], s6 offen nt
  s_mov_b32 s6, 98304
  buffer_load_dwordx4 v[68:71], v2, s[36:39], s6 offen nt
  s_mov_b32 s6, 196608
  buffer_load_dwordx4 v[72:75], v2, s[36:39], s6 offen nt
  s_mov_b32 s6, 294912
  buffer_load_dwordx4 v[76:79], v2, s[36:39], s6 offen nt
  s_mov_b32 s6, 393216
  buffer_load_dwordx4 v[80:83], v2, s[36:39], s6 offen nt
  s_mov_b32 s6, 491520
  buffer_load_dwordx4 v[84:87], v2, s[36:39], s6 offen nt
  s_mov_b32 s6, 589824
  buffer_load_dwordx4 v[88:91], v2, s[36:39], s6 offen nt
  s_mov_b32 s6, 688128
  buffer_load_dwordx4 v[92:95], v2, s[36:39], s6 offen nt
  s_mov_b32 s6, 786432
  buffer_load_dwordx4 v[96:99], v2, s[36:39], s6 offen nt
  s_mov_b32 s6, 884736
  buffer_load_dwordx4 v[100:103], v2, s[36:39], s6 offen nt
  s_barrier
  s_waitcnt vmcnt(10)
  v_lshlrev_b32 v10, 16, v4
  v_and_b32 v11, 0xffff0000, v4
  v_lshlrev_b32 v12, 16, v5
  v_and_b32 v13, 0xffff0000, v5
  v_lshlrev_b32 v14, 16, v6
  v_and_b32 v15, 0xffff0000, v6
  v_lshlrev_b32 v16, 16, v7
  v_and_b32 v17, 0xffff0000, v7
  v_lshlrev_b32 v18, 16, v8
  v_and_b32 v19, 0xffff0000, v8
  v_add_f32 v20, v10, v11
  v_add_f32 v20, v20, v12
  v_add_f32 v20, v20, v13
  v_add_f32 v20, v20, v14
  v_add_f32 v20, v20, v15
  v_add_f32 v20, v20, v16
  v_add_f32 v20, v20, v17
  v_add_f32 v20, v20, v18
  v_add_f32 v20, v20, v19
  s_nop 1
  v_add_f32_dpp v20, v20, v20 row_ror:1 row_mask:0xf bank_mask:0xf
  s_nop 1
  v_add_f32_dpp v20, v20, v20 row_ror:2 row_mask:0xf bank_mask:0xf
  s_nop 1
  v_add_f32_dpp v20, v20, v20 row_ror:4 row_mask:0xf bank_mask:0xf
  s_nop 1
  v_add_f32_dpp v20, v20, v20 row_ror:8 row_mask:0xf bank_mask:0xf
  v_mov_b32 v21, v20
  s_nop 1
  v_permlane16_swap_b32 v20, v21
  v_add_f32 v20, v20, v21
  v_mov_b32 v21, v20
  s_nop 1
  v_permlane32_swap_b32 v20, v21
  v_add_f32 v20, v20, v21
  v_mul_f32 v22, 0x3acccccd, v20
  v_sub_f32 v21, v10, v22
  v_mul_f32 v20, v21, v21
  v_sub_f32 v21, v11, v22
  v_fmac_f32 v20, v21, v21
  v_sub_f32 v21, v12, v22
  v_fmac_f32 v20, v21, v21
  v_sub_f32 v21, v13, v22
  v_fmac_f32 v20, v21, v21
  v_sub_f32 v21, v14, v22
  v_fmac_f32 v20, v21, v21
  v_sub_f32 v21, v15, v22
  v_fmac_f32 v20, v21, v21
  v_sub_f32 v21, v16, v22
  v_fmac_f32 v20, v21, v21
  v_sub_f32 v21, v17, v22
  v_fmac_f32 v20, v21, v21
  v_sub_f32 v21, v18, v22
  v_fmac_f32 v20, v21, v21
  v_sub_f32 v21, v19, v22
  v_fmac_f32 v20, v21, v21
  s_nop 1
  v_add_f32_dpp v20, v20, v20 row_ror:1 row_mask:0xf bank_mask:0xf
  s_nop 1
  v_add_f32_dpp v20, v20, v20 row_ror:2 row_mask:0xf bank_mask:0xf
  s_nop 1
  v_add_f32_dpp v20, v20, v20 row_ror:4 row_mask:0xf bank_mask:0xf
  s_nop 1
  v_add_f32_dpp v20, v20, v20 row_ror:8 row_mask:0xf bank_mask:0xf
  v_mov_b32 v21, v20
  s_nop 1
  v_permlane16_swap_b32 v20, v21
  v_add_f32 v20, v20, v21
  v_mov_b32 v21, v20
  s_nop 1
  v_permlane32_swap_b32 v20, v21
  v_add_f32 v20, v20, v21
  v_mul_f32 v20, 0x3acccccd, v20
  v_cvt_pk_bf16_f32 v21, v20, v22
  v_lshlrev_b32 v20, 16, v21
  v_and_b32 v22, 0xffff0000, v21
  v_add_f32 v20, 0x3727c5ac, v20
  v_cvt_pk_bf16_f32 v20, v20, v20
  v_lshlrev_b32 v20, 16, v20
  v_sqrt_f32 v20, v20
  s_nop 0
  v_cvt_pk_bf16_f32 v20, v20, v20
  v_lshlrev_b32 v20, 16, v20
  v_rcp_f32 v20, v20
  v_sub_f32 v10, v10, v22
  v_sub_f32 v11, v11, v22
  v_sub_f32 v12, v12, v22
  v_sub_f32 v13, v13, v22
  v_sub_f32 v14, v14, v22
  v_sub_f32 v15, v15, v22
  v_sub_f32 v16, v16, v22
  v_sub_f32 v17, v17, v22
  v_sub_f32 v18, v18, v22
  v_sub_f32 v19, v19, v22
  v_cvt_pk_bf16_f32 v4, v10, v11
  v_cvt_pk_bf16_f32 v5, v12, v13
  v_cvt_pk_bf16_f32 v6, v14, v15
  v_cvt_pk_bf16_f32 v7, v16, v17
  v_cvt_pk_bf16_f32 v8, v18, v19
  v_lshlrev_b32 v10, 16, v4
  v_and_b32 v11, 0xffff0000, v4
  v_lshlrev_b32 v12, 16, v5
  v_and_b32 v13, 0xffff0000, v5
  v_lshlrev_b32 v14, 16, v6
  v_and_b32 v15, 0xffff0000, v6
  v_lshlrev_b32 v16, 16, v7
  v_and_b32 v17, 0xffff0000, v7
  v_lshlrev_b32 v18, 16, v8
  v_and_b32 v19, 0xffff0000, v8
  v_mul_f32 v10, v10, v20
  v_mul_f32 v11, v11, v20
  v_mul_f32 v12, v12, v20
  v_mul_f32 v13, v13, v20
  v_mul_f32 v14, v14, v20
  v_mul_f32 v15, v15, v20
  v_mul_f32 v16, v16, v20
  v_mul_f32 v17, v17, v20
  v_mul_f32 v18, v18, v20
  v_mul_f32 v19, v19, v20
  v_cvt_pk_bf16_f32 v4, v10, v11
  v_cvt_pk_bf16_f32 v5, v12, v13
  v_cvt_pk_bf16_f32 v6, v14, v15
  v_cvt_pk_bf16_f32 v7, v16, v17
  v_cvt_pk_bf16_f32 v8, v18, v19
  v_lshlrev_b32 v21, 2, v0
  ds_write_b32 v21, v4 offset:1280
  ds_write_b32 v21, v5 offset:1536
  ds_write_b32 v21, v6 offset:1792
  ds_write_b32 v21, v7 offset:2048
  ds_write_b32 v21, v8 offset:2304
  v_lshrrev_b32 v20, 3, v0
  s_mul_i32 s6, s5, 80
  v_add_u32 v20, s6, v20
  v_lshlrev_b32 v20, 1, v20
  s_waitcnt lgkmcnt(0)
  ds_read_u16 v24, v20 offset:1280
  ds_read_u16 v25, v20 offset:1296
  ds_read_u16 v26, v20 offset:1312
  ds_read_u16 v27, v20 offset:1328
  ds_read_u16 v28, v20 offset:1344
  ds_read_u16 v29, v20 offset:1360
  ds_read_u16 v30, v20 offset:1376
  ds_read_u16 v31, v20 offset:1392
  ds_read_u16 v32, v20 offset:1408
  ds_read_u16 v33, v20 offset:1424
  s_waitcnt lgkmcnt(0)
  v_lshlrev_b32 v34, 16, v24
  v_lshlrev_b32 v35, 16, v25
  v_lshlrev_b32 v36, 16, v26
  v_lshlrev_b32 v37, 16, v27
  v_lshlrev_b32 v38, 16, v28
  v_lshlrev_b32 v39, 16, v29
  v_lshlrev_b32 v40, 16, v30
  v_lshlrev_b32 v41, 16, v31
  v_lshlrev_b32 v42, 16, v32
  v_lshlrev_b32 v43, 16, v33
  s_waitcnt vmcnt(0)
  v_dot2_f32_bf16 v44, v64, v24, 0
  v_dot2_f32_bf16 v45, v64, v34, 0
  v_dot2_f32_bf16 v46, v65, v24, 0
  v_dot2_f32_bf16 v47, v65, v34, 0
  v_dot2_f32_bf16 v48, v66, v24, 0
  v_dot2_f32_bf16 v49, v66, v34, 0
  v_dot2_f32_bf16 v50, v67, v24, 0
  v_dot2_f32_bf16 v51, v67, v34, 0
  v_dot2_f32_bf16 v44, v68, v25, v44
  v_dot2_f32_bf16 v45, v68, v35, v45
  v_dot2_f32_bf16 v46, v69, v25, v46
  v_dot2_f32_bf16 v47, v69, v35, v47
  v_dot2_f32_bf16 v48, v70, v25, v48
  v_dot2_f32_bf16 v49, v70, v35, v49
  v_dot2_f32_bf16 v50, v71, v25, v50
  v_dot2_f32_bf16 v51, v71, v35, v51
  v_dot2_f32_bf16 v44, v72, v26, v44
  v_dot2_f32_bf16 v45, v72, v36, v45
  v_dot2_f32_bf16 v46, v73, v26, v46
  v_dot2_f32_bf16 v47, v73, v36, v47
  v_dot2_f32_bf16 v48, v74, v26, v48
  v_dot2_f32_bf16 v49, v74, v36, v49
  v_dot2_f32_bf16 v50, v75, v26, v50
  v_dot2_f32_bf16 v51, v75, v36, v51
  v_dot2_f32_bf16 v44, v76, v27, v44
  v_dot2_f32_bf16 v45, v76, v37, v45
  v_dot2_f32_bf16 v46, v77, v27, v46
  v_dot2_f32_bf16 v47, v77, v37, v47
  v_dot2_f32_bf16 v48, v78, v27, v48
  v_dot2_f32_bf16 v49, v78, v37, v49
  v_dot2_f32_bf16 v50, v79, v27, v50
  v_dot2_f32_bf16 v51, v79, v37, v51
  v_dot2_f32_bf16 v44, v80, v28, v44
  v_dot2_f32_bf16 v45, v80, v38, v45
  v_dot2_f32_bf16 v46, v81, v28, v46
  v_dot2_f32_bf16 v47, v81, v38, v47
  v_dot2_f32_bf16 v48, v82, v28, v48
  v_dot2_f32_bf16 v49, v82, v38, v49
  v_dot2_f32_bf16 v50, v83, v28, v50
  v_dot2_f32_bf16 v51, v83, v38, v51
  v_dot2_f32_bf16 v44, v84, v29, v44
  v_dot2_f32_bf16 v45, v84, v39, v45
  v_dot2_f32_bf16 v46, v85, v29, v46
  v_dot2_f32_bf16 v47, v85, v39, v47
  v_dot2_f32_bf16 v48, v86, v29, v48
  v_dot2_f32_bf16 v49, v86, v39, v49
  v_dot2_f32_bf16 v50, v87, v29, v50
  v_dot2_f32_bf16 v51, v87, v39, v51
  v_dot2_f32_bf16 v44, v88, v30, v44
  v_dot2_f32_bf16 v45, v88, v40, v45
  v_dot2_f32_bf16 v46, v89, v30, v46
  v_dot2_f32_bf16 v47, v89, v40, v47
  v_dot2_f32_bf16 v48, v90, v30, v48
  v_dot2_f32_bf16 v49, v90, v40, v49
  v_dot2_f32_bf16 v50, v91, v30, v50
  v_dot2_f32_bf16 v51, v91, v40, v51
  v_dot2_f32_bf16 v44, v92, v31, v44
  v_dot2_f32_bf16 v45, v92, v41, v45
  v_dot2_f32_bf16 v46, v93, v31, v46
  v_dot2_f32_bf16 v47, v93, v41, v47
  v_dot2_f32_bf16 v48, v94, v31, v48
  v_dot2_f32_bf16 v49, v94, v41, v49
  v_dot2_f32_bf16 v50, v95, v31, v50
  v_dot2_f32_bf16 v51, v95, v41, v51
  v_dot2_f32_bf16 v44, v96, v32, v44
  v_dot2_f32_bf16 v45, v96, v42, v45
  v_dot2_f32_bf16 v46, v97, v32, v46
  v_dot2_f32_bf16 v47, v97, v42, v47
  v_dot2_f32_bf16 v48, v98, v32, v48
  v_dot2_f32_bf16 v49, v98, v42, v49
  v_dot2_f32_bf16 v50, v99, v32, v50
  v_dot2_f32_bf16 v51, v99, v42, v51
  v_dot2_f32_bf16 v44, v100, v33, v44
  v_dot2_f32_bf16 v45, v100, v43, v45
  v_dot2_f32_bf16 v46, v101, v33, v46
  v_dot2_f32_bf16 v47, v101, v43, v47
  v_dot2_f32_bf16 v48, v102, v33, v48
  v_dot2_f32_bf16 v49, v102, v43, v49
  v_dot2_f32_bf16 v50, v103, v33, v50
  v_dot2_f32_bf16 v51, v103, v43, v51
  v_permlane32_swap_b32 v44, v48
  v_permlane32_swap_b32 v45, v49
  v_permlane32_swap_b32 v46, v50
  v_permlane32_swap_b32 v47, v51
  v_add_f32 v44, v44, v48
  v_add_f32 v45, v45, v49
  v_add_f32 v46, v46, v50
  v_add_f32 v47, v47, v51
  s_nop 0
  v_permlane16_swap_b32 v44, v46
  v_permlane16_swap_b32 v45, v47
  v_add_f32 v44, v44, v46
  v_add_f32 v45, v45, v47
  s_nop 0
  v_add_f32_dpp v21, v44, v44 row_ror:8 row_mask:0xf bank_mask:0x3
  s_nop 1
  v_add_f32_dpp v21, v45, v45 row_ror:8 row_mask:0xf bank_mask:0xc
  v_min_u32 v21, -2, v21
  s_mul_i32 s6, s4, 10240
  s_lshl_b32 s56, s7, 8
  s_add_u32 s6, s6, s56
  v_add_u32 v14, s6, v1
  s_mul_i32 s56, s5, 1280
  v_add_u32 v15, s56, v14
  v_mov_b32 v12, 0
  s_mov_b32 s57, 0
L_clr_11:
  ds_read_b32 v13, v12 offset:396
  s_waitcnt lgkmcnt(0)
  v_readfirstlane_b32 s58, v13
  s_add_u32 s57, s57, 1
  s_cmp_gt_u32 s57, 240000
  s_cbranch_scc1 L_clrd_12
  s_cmp_lg_u32 s58, 0
  s_cbranch_scc1 L_clrd_12
  s_sleep 1
  s_branch L_clr_11
L_clrd_12:
  buffer_store_dword v21, v15, s[44:47], 0 offen sc1
  s_mov_b32 s57, 0
L_mode_13:
  ds_read_b32 v13, v12 offset:384
  s_waitcnt lgkmcnt(0)
  v_readfirstlane_b32 s59, v13
  s_add_u32 s57, s57, 1
  s_cmp_gt_u32 s57, 240000
  s_cbranch_scc1 L_moded_14
  s_cmp_lg_u32 s59, 0
  s_cbranch_scc1 L_moded_14
  s_sleep 1
  s_branch L_mode_13
L_moded_14:
  s_mov_b32 s57, 0
L_h1_15:
  buffer_load_dword v64, v14, s[44:47], 0 offen sc1
  buffer_load_dword v65, v14, s[44:47], 0 offen offset:1280 sc1
  buffer_load_dword v66, v14, s[44:47], s60 offen sc1
  buffer_load_dword v67, v14, s[44:47], s60 offen offset:1280 sc1
  buffer_load_dword v68, v14, s[44:47], s61 offen sc1
  buffer_load_dword v69, v14, s[44:47], s61 offen offset:1280 sc1
  buffer_load_dword v70, v14, s[44:47], s62 offen sc1
  buffer_load_dword v71, v14, s[44:47], s62 offen offset:1280 sc1
  s_waitcnt vmcnt(0)
  v_max3_u32 v72, v64, v65, v66
  v_max3_u32 v72, v72, v67, v68
  v_max3_u32 v72, v72, v69, v70
  v_max_u32 v72, v72, v71
  v_cmp_eq_u32 vcc, -1, v72
  s_add_u32 s57, s57, 1
  s_cmp_gt_u32 s57, 30000
  s_cbranch_scc1 L_h1d_16
  s_cbranch_vccz L_h1d_16
  s_sleep 2
  s_branch L_h1_15
L_h1d_16:
  v_add_f32 v64, v64, v65
  v_add_f32 v66, v66, v67
  v_add_f32 v68, v68, v69
  v_add_f32 v70, v70, v71
  v_add_f32 v64, v64, v66
  v_add_f32 v68, v68, v70
  v_add_f32 v64, v64, v68
  v_cvt_pk_bf16_f32 v64, v64, v64
  v_and_b32 v16, 7, v0
  v_lshrrev_b32 v17, 3, v0
  v_lshl_add_u32 v16, v16, 3, v17
  s_lshl_b32 s6, s7, 6
  v_add_u32 v16, s6, v16
  v_lshlrev_b32 v16, 1, v16
  ds_write_b16 v16, v64 offset:0
  v_mov_b32 v13, 1
  s_waitcnt lgkmcnt(0)
  s_mov_b64 exec, 1
  ds_add_u32 v12, v13 offset:392
  s_mov_b64 exec, -1
  s_cmp_eq_u32 s3, 8
  s_cbranch_scc1 L_h0
  s_cmp_eq_u32 s3, 10
  s_cbranch_scc1 L_h2
  s_mov_b32 s56, -1
  s_cmp_eq_u32 s4, 1
  s_cselect_b32 s56, 0, s56
  s_cmp_eq_u32 s4, 7
  s_cselect_b32 s56, 1, s56
  s_cmp_eq_u32 s4, 13
  s_cselect_b32 s56, 2, s56
  s_cmp_eq_u32 s4, 19
  s_cselect_b32 s56, 3, s56
  s_cmp_eq_u32 s4, 25
  s_cselect_b32 s56, 4, s56
  s_cmp_eq_u32 s56, -1
  s_cbranch_scc1 L_exit_stamped
  v_mov_b32 v12, 0
  s_mov_b32 s55, s56
  s_mov_b32 s57, 0
L_allc_17:
  ds_read_b32 v13, v12 offset:464
  s_waitcnt lgkmcnt(0)
  v_readfirstlane_b32 s58, v13
  s_add_u32 s57, s57, 1
  s_cmp_gt_u32 s57, 240000
  s_cbranch_scc1 L_allcd_18
  s_cmp_lg_u32 s58, 0
  s_cbranch_scc1 L_allcd_18
  s_sleep 4
  s_branch L_allc_17
L_allcd_18:
  s_mul_i32 s7, s5, 5
  s_add_u32 s55, s55, s7
  s_mul_i32 s6, s55, 8448
  s_add_u32 s6, s6, 524288
  v_lshlrev_b32 v14, 4, v0
  v_add_u32 v14, s6, v14
  v_add_u32 v13, 6144, v14
  v_and_b32 v15, 3, v0
  v_lshlrev_b32 v15, 2, v15
  v_lshrrev_b32 v16, 5, v0
  v_lshl_add_u32 v15, v16, 1, v15
  v_bfe_u32 v16, v0, 4, 1
  v_add_u32 v15, v15, v16
  s_lshl_b32 s6, s55, 4
  v_add_u32 v15, s6, v15
  v_lshlrev_b32 v15, 1, v15
  buffer_load_ushort v17, v15, s[32:35], 0 offen
  s_mov_b32 s40, s26
  s_mov_b32 s41, s27
  s_mov_b32 s42, 1280
  s_mov_b32 s43, 0x20000
  v_mov_b32 v28, 0
  v_mov_b32 v29, 0
  v_mov_b32 v30, 0
  v_mov_b32 v31, 0
  s_mov_b32 s57, 0
L_dl_19:
  ds_read_b32 v16, v12 offset:488
  s_waitcnt lgkmcnt(0)
  v_readfirstlane_b32 s58, v16
  s_add_u32 s57, s57, 1
  s_cmp_gt_u32 s57, 240000
  s_cbranch_scc1 L_dld_20
  s_cmp_lg_u32 s58, 0
  s_cbranch_scc1 L_dld_20
  s_sleep 8
  s_branch L_dl_19
L_dld_20:
  s_mov_b32 s57, 0
L_pollD_21:
  buffer_load_dwordx4 v[24:27], v13, s[44:47], 0 offen sc1
  s_mov_b32 exec_hi, 0
  buffer_load_dwordx4 v[28:31], v13, s[44:47], 0 offen offset:1024 sc1
  s_mov_b32 exec_hi, -1
  s_waitcnt vmcnt(0)
  v_max3_u32 v32, v24, v25, v26
  v_max3_u32 v32, v32, v27, v28
  v_max3_u32 v32, v32, v29, v30
  v_max_u32 v32, v32, v31
  v_cmp_eq_u32 vcc, -1, v32
  s_add_u32 s57, s57, 1
  s_cmp_gt_u32 s57, 30000
  s_cbranch_scc1 L_pollDd_22
  s_cbranch_vccz L_pollDd_22
  s_sleep 8
  s_branch L_pollD_21
L_pollDd_22:
  v_add_f32 v24, v24, v28
  v_add_f32 v25, v25, v29
  v_add_f32 v26, v26, v30
  v_add_f32 v27, v27, v31
  s_nop 0
  v_permlane32_swap_b32 v24, v26
  v_permlane32_swap_b32 v25, v27
  v_add_f32 v24, v24, v26
  v_add_f32 v25, v25, v27
  s_nop 1
  v_permlane16_swap_b32 v24, v25
  v_add_f32 v24, v24, v25
  s_nop 1
  v_add_f32_dpp v24, v24, v24 row_ror:4 row_mask:0xf bank_mask:0xf
  s_nop 1
  v_add_f32_dpp v24, v24, v24 row_ror:8 row_mask:0xf bank_mask:0xf
  v_cvt_pk_bf16_f32 v24, v24, v24
  v_lshlrev_b32 v24, 16, v24
  v_mul_f32 v25, 0xbfb8aa3b, v24
  v_exp_f32 v25, v25
  s_nop 0
  v_add_f32 v25, 1.0, v25
  v_rcp_f32 v25, v25
  s_nop 0
  v_mul_f32 v24, v24, v25
  v_cvt_pk_bf16_f32 v24, v24, v24
  v_lshlrev_b32 v18, 16, v24
  v_lshlrev_b32 v17, 16, v17
  s_barrier
  s_cmp_ge_u32 s55, 32
  s_cbranch_scc1 L_big_23
  s_mov_b32 s57, 0
L_pollS_24:
  buffer_load_dwordx4 v[24:27], v14, s[44:47], 0 offen sc1
  buffer_load_dwordx4 v[28:31], v14, s[44:47], 0 offen offset:1024 sc1
  s_waitcnt vmcnt(0)
  v_max3_u32 v32, v24, v25, v26
  v_max3_u32 v32, v32, v27, v28
  v_max3_u32 v32, v32, v29, v30
  v_max_u32 v32, v32, v31
  v_cmp_eq_u32 vcc, -1, v32
  s_add_u32 s57, s57, 1
  s_cmp_gt_u32 s57, 30000
  s_cbranch_scc1 L_pollSd_25
  s_cbranch_vccnz L_pollS_24
L_pollSd_25:
  v_add_f32 v24, v24, v28
  v_add_f32 v25, v25, v29
  v_add_f32 v26, v26, v30
  v_add_f32 v27, v27, v31
  s_nop 0
  v_permlane32_swap_b32 v24, v26
  v_permlane32_swap_b32 v25, v27
  v_add_f32 v24, v24, v26
  v_add_f32 v25, v25, v27
  s_nop 1
  v_permlane16_swap_b32 v24, v25
  v_add_f32 v24, v24, v25
  s_nop 1
  v_add_f32_dpp v24, v24, v24 row_ror:4 row_mask:0xf bank_mask:0xf
  s_nop 1
  v_add_f32_dpp v24, v24, v24 row_ror:8 row_mask:0xf bank_mask:0xf
  v_cvt_pk_bf16_f32 v24, v24, v24
  v_lshlrev_b32 v24, 16, v24
  v_mul_f32 v24, v24, v18
  v_cvt_pk_bf16_f32 v24, v24, v24
  v_lshlrev_b32 v24, 16, v24
  v_add_f32 v24, v17, v24
  v_cvt_pk_bf16_f32 v24, v24, v24
  s_mov_b32 exec_lo, 0x000f000f
  s_mov_b32 exec_hi, 0x000f000f
  buffer_store_short v24, v15, s[40:43], 0 offen
  s_mov_b64 exec, -1
  s_branch L_exit_stamped
L_big_23:
  v_add_u32 v13, 4096, v14
  s_mov_b32 s57, 0
L_pollS6_26:
  buffer_load_dwordx4 v[24:27], v14, s[44:47], 0 offen sc1
  buffer_load_dwordx4 v[28:31], v14, s[44:47], 0 offen offset:1024 sc1
  buffer_load_dwordx4 v[32:35], v14, s[44:47], 0 offen offset:2048 sc1
  buffer_load_dwordx4 v[36:39], v14, s[44:47], 0 offen offset:3072 sc1
  buffer_load_dwordx4 v[40:43], v13, s[44:47], 0 offen sc1
  buffer_load_dwordx4 v[44:47], v13, s[44:47], 0 offen offset:1024 sc1
  s_waitcnt vmcnt(0)
  v_max3_u32 v48, v24, v25, v26
  v_max3_u32 v48, v48, v27, v28
  v_max3_u32 v48, v48, v29, v30
  v_max3_u32 v48, v48, v31, v32
  v_max3_u32 v48, v48, v33, v34
  v_max3_u32 v48, v48, v35, v36
  v_max3_u32 v48, v48, v37, v38
  v_max3_u32 v48, v48, v39, v40
  v_max3_u32 v48, v48, v41, v42
  v_max3_u32 v48, v48, v43, v44
  v_max3_u32 v48, v48, v45, v46
  v_max_u32 v48, v48, v47
  v_cmp_eq_u32 vcc, -1, v48
  s_add_u32 s57, s57, 1
  s_cmp_gt_u32 s57, 30000
  s_cbranch_scc1 L_pollS6d_27
  s_cbranch_vccnz L_pollS6_26
L_pollS6d_27:
  v_add_f32 v24, v24, v32
  v_add_f32 v25, v25, v33
  v_add_f32 v26, v26, v34
  v_add_f32 v27, v27, v35
  v_add_f32 v28, v28, v36
  v_add_f32 v29, v29, v37
  v_add_f32 v30, v30, v38
  v_add_f32 v31, v31, v39
  v_add_f32 v24, v24, v40
  v_add_f32 v25, v25, v41
  v_add_f32 v26, v26, v42
  v_add_f32 v27, v27, v43
  v_add_f32 v28, v28, v44
  v_add_f32 v29, v29, v45
  v_add_f32 v30, v30, v46
  v_add_f32 v31, v31, v47
  v_add_f32 v24, v24, v28
  v_add_f32 v25, v25, v29
  v_add_f32 v26, v26, v30
  v_add_f32 v27, v27, v31
  s_nop 0
  v_permlane32_swap_b32 v24, v26
  v_permlane32_swap_b32 v25, v27
  v_add_f32 v24, v24, v26
  v_add_f32 v25, v25, v27
  s_nop 1
  v_permlane16_swap_b32 v24, v25
  v_add_f32 v24, v24, v25
  s_nop 1
  v_add_f32_dpp v24, v24, v24 row_ror:4 row_mask:0xf bank_mask:0xf
  s_nop 1
  v_add_f32_dpp v24, v24, v24 row_ror:8 row_mask:0xf bank_mask:0xf
  v_cvt_pk_bf16_f32 v24, v24, v24
  v_lshlrev_b32 v24, 16, v24
  v_mul_f32 v24, v24, v18
  v_cvt_pk_bf16_f32 v24, v24, v24
  v_lshlrev_b32 v24, 16, v24
  v_add_f32 v24, v17, v24
  v_cvt_pk_bf16_f32 v24, v24, v24
  s_mov_b32 exec_lo, 0x000f000f
  s_mov_b32 exec_hi, 0x000f000f
  buffer_store_short v24, v15, s[40:43], 0 offen
  s_mov_b64 exec, -1
  s_branch L_exit_stamped
L_h2:
  s_setprio 0
  s_mul_i32 s6, s4, 245760
  s_lshl_b32 s56, s5, 7
  s_add_u32 s6, s6, s56
  s_add_u32 s40, s16, s6
  s_addc_u32 s41, s17, 0
  s_mov_b32 s42, 244608
  s_mov_b32 s43, 0x20000
  v_lshrrev_b32 v2, 3, v0
  v_and_b32 v3, 3, v2
  v_lshlrev_b32 v3, 1, v3
  v_and_b32 v4, 7, v0
  v_xor_b32 v3, v3, v4
  v_mul_u32_u24 v2, 1280, v2
  v_lshl_add_u32 v2, v3, 4, v2
  s_mov_b32 s6, 0
  s_mov_b32 m0, 4096
  s_cmp_ge_u32 s5, 3
  s_cselect_b32 s7, 128, 0
  s_cselect_b32 s56, 3, 0
  s_sub_u32 s56, s5, s56
  s_mul_i32 s56, s56, 81920
  s_add_u32 s7, s7, s56
  s_mul_i32 s6, s4, 245760
  s_add_u32 s6, s6, s7
  s_add_u32 s6, s6, 1024
  s_add_u32 s52, s16, s6
  s_addc_u32 s53, s17, 0
  s_mov_b32 s54, 80768
  s_mov_b32 s55, 0x20000
  s_mov_b32 m0, 4096
  s_mov_b32 s6, 0
  v_mov_b32 v12, 0
  s_mov_b32 s57, 0
L_wol_28:
  ds_read_b32 v13, v12 offset:472
  s_waitcnt lgkmcnt(0)
  v_readfirstlane_b32 s58, v13
  s_add_u32 s57, s57, 1
  s_cmp_gt_u32 s57, 240000
  s_cbranch_scc1 L_wold_29
  s_cmp_ge_u32 s58, 6
  s_cbranch_scc1 L_wold_29
  s_sleep 2
  s_branch L_wol_28
L_wold_29:
L_wo_loop:
  buffer_load_dwordx4 v2, s[40:43], s6 offen nt lds
  s_add_u32 m0, m0, 1024
  s_add_u32 s6, s6, 10240
  s_cmp_lt_u32 s6, 245760
  s_cbranch_scc1 L_wo_loop
  s_cmp_ge_u32 s5, 6
  s_cbranch_scc1 L_wo_done
  s_mov_b32 s6, 0
L_wo2_loop:
  buffer_load_dwordx4 v2, s[52:55], s6 offen nt lds
  s_add_u32 m0, m0, 1024
  s_add_u32 s6, s6, 10240
  s_cmp_lt_u32 s6, 81920
  s_cbranch_scc1 L_wo2_loop
L_wo_done:
  s_waitcnt vmcnt(0)
  v_mov_b32 v13, 1
  s_mov_b64 exec, 1
  ds_write_b32 v12, v13 offset:476
  s_mov_b64 exec, -1
  s_branch L_exit_stamped
L_h0:
  v_mov_b32 v12, 0
  s_mov_b32 s57, 0
L_cnt_30:
  ds_read_b32 v13, v12 offset:388
  s_waitcnt lgkmcnt(0)
  v_readfirstlane_b32 s58, v13
  s_add_u32 s57, s57, 1
  s_cmp_gt_u32 s57, 240000
  s_cbranch_scc1 L_cntd_31
  s_cmp_eq_u32 s58, 8
  s_cbranch_scc1 L_cntd_31
  s_sleep 2
  s_branch L_cnt_30
L_cntd_31:
  v_and_b32 v14, 7, v0
  v_lshlrev_b32 v14, 2, v14
  ds_read_b32 v16, v14 offset:400
  ds_read_b32 v17, v14 offset:432
  s_waitcnt lgkmcnt(0)
  v_mov_b32 v18, v16
  s_nop 1
  v_max_f32_dpp v18, v18, v18 row_ror:1 row_mask:0xf bank_mask:0xf
  s_nop 1
  v_max_f32_dpp v18, v18, v18 row_ror:2 row_mask:0xf bank_mask:0xf
  s_nop 1
  v_max_f32_dpp v18, v18, v18 row_ror:4 row_mask:0xf bank_mask:0xf
  v_sub_f32 v19, v16, v18
  v_mul_f32 v19, 0x3fb8aa3b, v19
  v_exp_f32 v19, v19
  s_nop 0
  v_mul_f32 v19, v19, v17
  s_nop 1
  v_add_f32_dpp v19, v19, v19 row_ror:1 row_mask:0xf bank_mask:0xf
  s_nop 1
  v_add_f32_dpp v19, v19, v19 row_ror:2 row_mask:0xf bank_mask:0xf
  s_nop 1
  v_add_f32_dpp v19, v19, v19 row_ror:4 row_mask:0xf bank_mask:0xf
  v_min_u32 v20, -2, v18
  v_min_u32 v21, -2, v19
  v_mov_b32 v16, v18
  s_mul_i32 s6, s4, 10240
  s_mul_i32 s56, s5, 1280
  s_add_u32 s6, s6, s56
  s_add_u32 s6, s6, 1152
  v_mov_b32 v15, s6
  s_mov_b64 exec, 1
  s_cmp_eq_u32 s59, 2
  s_cbranch_scc1 L_fast_32
  buffer_store_dwordx2 v[20:21], v15, s[44:47], 0 offen sc1
  s_branch L_join_33
L_fast_32:
  buffer_store_dwordx2 v[20:21], v15, s[44:47], 0 offen
L_join_33:
  s_mov_b64 exec, -1
  v_and_b32 v15, 7, v0
  v_mul_u32_u24 v15, 1280, v15
  s_mul_i32 s6, s4, 10240
  s_add_u32 s6, s6, 1152
  v_add_u32 v15, s6, v15
  s_mov_b32 s57, 0
L_lse_34:
  buffer_load_dwordx2 v[22:23], v15, s[44:47], 0 offen sc1
  s_waitcnt vmcnt(0)
  v_max_u32 v24, v22, v23
  v_cmp_eq_u32 vcc, -1, v24
  s_add_u32 s57, s57, 1
  s_cmp_gt_u32 s57, 30000
  s_cbranch_scc1 L_lsed_35
  s_cbranch_vccz L_lsed_35
  s_sleep 1
  s_branch L_lse_34
L_lsed_35:
  v_mov_b32 v18, v22
  s_nop 1
  v_max_f32_dpp v18, v18, v18 row_ror:1 row_mask:0xf bank_mask:0xf
  s_nop 1
  v_max_f32_dpp v18, v18, v18 row_ror:2 row_mask:0xf bank_mask:0xf
  s_nop 1
  v_max_f32_dpp v18, v18, v18 row_ror:4 row_mask:0xf bank_mask:0xf
  v_sub_f32 v19, v22, v18
  v_mul_f32 v19, 0x3fb8aa3b, v19
  v_exp_f32 v19, v19
  s_nop 0
  v_mul_f32 v19, v19, v23
  s_nop 1
  v_add_f32_dpp v19, v19, v19 row_ror:1 row_mask:0xf bank_mask:0xf
  s_nop 1
  v_add_f32_dpp v19, v19, v19 row_ror:2 row_mask:0xf bank_mask:0xf
  s_nop 1
  v_add_f32_dpp v19, v19, v19 row_ror:4 row_mask:0xf bank_mask:0xf
  v_rcp_f32 v19, v19
  v_sub_f32 v16, v16, v18
  v_mul_f32 v16, 0x3fb8aa3b, v16
  v_exp_f32 v16, v16
  s_nop 0
  v_mul_f32 v16, v16, v19
  v_mov_b32 v12, 0
  v_mov_b32 v13, 1
  ds_write_b32 v12, v13 offset:484
  v_lshlrev_b32 v14, 4, v0
  s_mul_i32 s6, s4, 10240
  s_mul_i32 s56, s5, 1280
  s_add_u32 s6, s6, s56
  s_add_u32 s6, s6, 768
  v_lshlrev_b32 v15, 3, v0
  v_add_u32 v15, s6, v15
  s_mul_i32 s6, s4, 10240
  s_add_u32 s6, s6, 768
  v_add_u32 v17, 0, v0
  v_mul_u32_u24 v18, 171, v17
  v_lshrrev_b32 v18, 12, v18
  v_mul_u32_u24 v19, 24, v18
  v_sub_u32 v19, v17, v19
  v_mul_u32_u24 v20, 1280, v18
  v_lshl_add_u32 v20, v19, 4, v20
  v_add_u32 v4, s6, v20
  v_mul_u32_u24 v20, 400, v18
  v_lshl_add_u32 v7, v19, 4, v20
  v_add_u32 v17, 64, v0
  v_mul_u32_u24 v18, 171, v17
  v_lshrrev_b32 v18, 12, v18
  v_mul_u32_u24 v19, 24, v18
  v_sub_u32 v19, v17, v19
  v_mul_u32_u24 v20, 1280, v18
  v_lshl_add_u32 v20, v19, 4, v20
  v_add_u32 v5, s6, v20
  v_mul_u32_u24 v20, 400, v18
  v_lshl_add_u32 v8, v19, 4, v20
  v_add_u32 v17, 128, v0
  v_mul_u32_u24 v18, 171, v17
  v_lshrrev_b32 v18, 12, v18
  v_mul_u32_u24 v19, 24, v18
  v_sub_u32 v19, v17, v19
  v_mul_u32_u24 v20, 1280, v18
  v_lshl_add_u32 v20, v19, 4, v20
  v_add_u32 v6, s6, v20
  v_mul_u32_u24 v20, 400, v18
  v_lshl_add_u32 v9, v19, 4, v20
  s_mov_b32 exec_hi, 0xffff
  v_mov_b32 v12, 0
  s_mov_b32 s57, 0
L_parts_36:
  ds_read_b32 v13, v12 offset:480
  s_waitcnt lgkmcnt(0)
  v_readfirstlane_b32 s58, v13
  s_add_u32 s57, s57, 1
  s_cmp_gt_u32 s57, 240000
  s_cbranch_scc1 L_partsd_37
  s_cmp_eq_u32 s58, 8
  s_cbranch_scc1 L_partsd_37
  s_branch L_parts_36
L_partsd_37:
  ds_read_b128 v[24:27], v14 offset:36864
  ds_read_b128 v[28:31], v14 offset:37632
  ds_read_b128 v[32:35], v14 offset:38400
  ds_read_b128 v[36:39], v14 offset:39168
  ds_read_b128 v[40:43], v14 offset:39936
  ds_read_b128 v[44:47], v14 offset:40704
  ds_read_b128 v[48:51], v14 offset:41472
  ds_read_b128 v[52:55], v14 offset:42240
  s_waitcnt lgkmcnt(6)
  v_add_f32 v24, v24, v28
  v_add_f32 v25, v25, v29
  v_add_f32 v26, v26, v30
  v_add_f32 v27, v27, v31
  s_waitcnt lgkmcnt(4)
  v_add_f32 v32, v32, v36
  v_add_f32 v33, v33, v37
  v_add_f32 v34, v34, v38
  v_add_f32 v35, v35, v39
  v_add_f32 v24, v24, v32
  v_add_f32 v25, v25, v33
  v_add_f32 v26, v26, v34
  v_add_f32 v27, v27, v35
  s_waitcnt lgkmcnt(2)
  v_add_f32 v40, v40, v44
  v_add_f32 v41, v41, v45
  v_add_f32 v42, v42, v46
  v_add_f32 v43, v43, v47
  s_waitcnt lgkmcnt(0)
  v_add_f32 v48, v48, v52
  v_add_f32 v49, v49, v53
  v_add_f32 v50, v50, v54
  v_add_f32 v51, v51, v55
  v_add_f32 v40, v40, v48
  v_add_f32 v41, v41, v49
  v_add_f32 v42, v42, v50
  v_add_f32 v43, v43, v51
  v_add_f32 v24, v24, v40
  v_add_f32 v25, v25, v41
  v_add_f32 v26, v26, v42
  v_add_f32 v27, v27, v43
  v_mul_f32 v24, v16, v24
  v_mul_f32 v25, v16, v25
  v_mul_f32 v26, v16, v26
  v_mul_f32 v27, v16, v27
  v_cvt_pk_bf16_f32 v20, v24, v25
  v_cvt_pk_bf16_f32 v21, v26, v27
  v_min_u32 v20, -2, v20
  v_min_u32 v21, -2, v21
  s_cmp_eq_u32 s59, 2
  s_cbranch_scc1 L_fast_38
  buffer_store_dwordx2 v[20:21], v15, s[44:47], 0 offen sc1
  s_branch L_join_39
L_fast_38:
  buffer_store_dwordx2 v[20:21], v15, s[44:47], 0 offen
L_join_39:
  s_mov_b64 exec, -1
  s_mov_b32 s57, 0
  buffer_load_dwordx4 v[56:59], v4, s[44:47], 0 offen sc1
  buffer_load_dwordx4 v[60:63], v5, s[44:47], 0 offen sc1
  buffer_load_dwordx4 v[64:67], v6, s[44:47], 0 offen sc1
  s_sleep 2
  buffer_load_dwordx4 v[68:71], v4, s[44:47], 0 offen sc1
  buffer_load_dwordx4 v[72:75], v5, s[44:47], 0 offen sc1
  buffer_load_dwordx4 v[76:79], v6, s[44:47], 0 offen sc1
  s_sleep 2
  buffer_load_dwordx4 v[80:83], v4, s[44:47], 0 offen sc1
  buffer_load_dwordx4 v[84:87], v5, s[44:47], 0 offen sc1
  buffer_load_dwordx4 v[88:91], v6, s[44:47], 0 offen sc1
  s_sleep 2
  buffer_load_dwordx4 v[92:95], v4, s[44:47], 0 offen sc1
  buffer_load_dwordx4 v[96:99], v5, s[44:47], 0 offen sc1
  buffer_load_dwordx4 v[100:103], v6, s[44:47], 0 offen sc1
L_pollA_40:
  s_waitcnt vmcnt(9)
  v_max3_u32 v17, v56, v57, v58
  v_max3_u32 v17, v17, v59, v60
  v_max3_u32 v17, v17, v61, v62
  v_max3_u32 v17, v17, v63, v64
  v_max3_u32 v17, v17, v65, v66
  v_max_u32 v17, v17, v67
  v_cmp_eq_u32 vcc, -1, v17
  s_cbranch_vccz L_pollAd0_42
  buffer_load_dwordx4 v[56:59], v4, s[44:47], 0 offen sc1
  buffer_load_dwordx4 v[60:63], v5, s[44:47], 0 offen sc1
  buffer_load_dwordx4 v[64:67], v6, s[44:47], 0 offen sc1
  s_waitcnt vmcnt(9)
  v_max3_u32 v17, v68, v69, v70
  v_max3_u32 v17, v17, v71, v72
  v_max3_u32 v17, v17, v73, v74
  v_max3_u32 v17, v17, v75, v76
  v_max3_u32 v17, v17, v77, v78
  v_max_u32 v17, v17, v79
  v_cmp_eq_u32 vcc, -1, v17
  s_cbranch_vccz L_pollAd1_43
  buffer_load_dwordx4 v[68:71], v4, s[44:47], 0 offen sc1
  buffer_load_dwordx4 v[72:75], v5, s[44:47], 0 offen sc1
  buffer_load_dwordx4 v[76:79], v6, s[44:47], 0 offen sc1
  s_waitcnt vmcnt(9)
  v_max3_u32 v17, v80, v81, v82
  v_max3_u32 v17, v17, v83, v84
  v_max3_u32 v17, v17, v85, v86
  v_max3_u32 v17, v17, v87, v88
  v_max3_u32 v17, v17, v89, v90
  v_max_u32 v17, v17, v91
  v_cmp_eq_u32 vcc, -1, v17
  s_cbranch_vccz L_pollAd2_44
  buffer_load_dwordx4 v[80:83], v4, s[44:47], 0 offen sc1
  buffer_load_dwordx4 v[84:87], v5, s[44:47], 0 offen sc1
  buffer_load_dwordx4 v[88:91], v6, s[44:47], 0 offen sc1
  s_waitcnt vmcnt(9)
  v_max3_u32 v17, v92, v93, v94
  v_max3_u32 v17, v17, v95, v96
  v_max3_u32 v17, v17, v97, v98
  v_max3_u32 v17, v17, v99, v100
  v_max3_u32 v17, v17, v101, v102
  v_max_u32 v17, v17, v103
  v_cmp_eq_u32 vcc, -1, v17
  s_cbranch_vccz L_pollAd3_45
  buffer_load_dwordx4 v[92:95], v4, s[44:47], 0 offen sc1
  buffer_load_dwordx4 v[96:99], v5, s[44:47], 0 offen sc1
  buffer_load_dwordx4 v[100:103], v6, s[44:47], 0 offen sc1
  s_add_u32 s57, s57, 1
  s_cmp_gt_u32 s57, 7500
  s_cbranch_scc0 L_pollA_40
L_pollAd0_42:
  ds_write_b128 v7, v[56:59] offset:43008
  ds_write_b128 v8, v[60:63] offset:43008
  ds_write_b128 v9, v[64:67] offset:43008
  s_branch L_pollAj_41
L_pollAd1_43:
  ds_write_b128 v7, v[68:71] offset:43008
  ds_write_b128 v8, v[72:75] offset:43008
  ds_write_b128 v9, v[76:79] offset:43008
  s_branch L_pollAj_41
L_pollAd2_44:
  ds_write_b128 v7, v[80:83] offset:43008
  ds_write_b128 v8, v[84:87] offset:43008
  ds_write_b128 v9, v[88:91] offset:43008
  s_branch L_pollAj_41
L_pollAd3_45:
  ds_write_b128 v7, v[92:95] offset:43008
  ds_write_b128 v8, v[96:99] offset:43008
  ds_write_b128 v9, v[100:103] offset:43008
L_pollAj_41:
  s_waitcnt lgkmcnt(0)
  s_barrier
  s_branch L_exit_stamped
L_h3:
  s_lshr_b32 s6, s2, 3
  s_sub_u32 s64, s6, 2
  s_cselect_b32 s66, 0, 1
  s_cselect_b32 s64, 0, s64
  s_mul_i32 s6, s64, 26
  s_lshr_b32 s6, s6, 8
  s_mul_i32 s56, s6, 10
  s_sub_u32 s64, s64, s56
  s_and_b32 s65, s2, 7
  s_mul_i32 s65, s65, 3
  s_add_u32 s65, s65, s6
  v_mov_b32 v16, 0
  v_mov_b32 v17, 0
  v_mov_b32 v18, 0
  v_mov_b32 v19, 0
  v_lshlrev_b32 v3, 4, v0
  v_mov_b32 v8, -1
  v_mov_b32 v9, -1
  v_mov_b32 v10, -1
  v_mov_b32 v11, -1
  s_mul_i32 s6, s4, 10240
  s_mul_i32 s56, s5, 1280
  s_add_u32 s6, s6, s56
  v_add_u32 v12, s6, v3
  v_mov_b32 v24, v12
  s_mul_i32 s56, s65, 10
  s_add_u32 s56, s56, s64
  s_mul_i32 s56, s56, 768
  s_add_u32 s67, s56, 327680
  s_cmp_lg_u32 s66, 0
  s_cselect_b32 s56, s67, 1879048192
  s_sub_u32 s56, s56, 256
  v_add_u32 v13, s56, v3
  v_add_u32 v12, 1024, v12
  v_cmp_gt_u32 vcc, 16, v0
  s_nop 1
  v_cndmask_b32 v12, v13, v12, vcc
  s_mov_b32 exec_hi, 0xffff
  s_lshl_b32 s6, s5, 2
  s_mul_i32 s6, s6, 8448
  s_lshl_b32 s56, s4, 6
  s_add_u32 s6, s6, s56
  s_add_u32 s6, s6, 524288
  v_mov_b32 v13, s6
  s_cmp_ge_u32 s5, 3
  s_cselect_b32 s7, 36, 32
  s_cselect_b32 s56, 3, 0
  s_sub_u32 s56, s5, s56
  s_mul_i32 s6, s7, 8448
  s_mul_i32 s7, s4, 3
  s_add_u32 s7, s7, s56
  s_lshl_b32 s7, s7, 6
  s_add_u32 s6, s6, s7
  s_add_u32 s6, s6, 524288
  s_cmp_ge_u32 s5, 6
  s_cselect_b32 s6, 1879048192, s6
  v_mov_b32 v14, s6
  s_lshl_b32 s6, s64, 2
  s_mul_i32 s6, s6, 8448
  s_lshl_b32 s56, s65, 6
  s_add_u32 s6, s6, s56
  s_add_u32 s68, s6, 530432
  s_cmp_lg_u32 s66, 0
  s_cselect_b32 s6, s68, 1879048192
  v_mov_b32 v15, s6
  v_cmp_gt_u32 vcc, 16, v0
  s_nop 1
  v_cndmask_b32 v14, v14, v13, vcc
  v_cmp_gt_u32 vcc, 32, v0
  s_nop 1
  v_cndmask_b32 v13, v15, v14, vcc
  v_bfe_u32 v14, v0, 2, 2
  v_mul_u32_u24 v14, 8448, v14
  v_add_u32 v13, v13, v14
  v_and_b32 v14, 3, v0
  v_lshl_add_u32 v13, v14, 4, v13
  s_mov_b32 exec_hi, 0
  s_mov_b32 exec_lo, 0xff
  ds_write_b128 v3, v[16:19] offset:384
  s_mov_b64 exec, -1
  s_waitcnt lgkmcnt(0)
  s_mov_b32 s44, s30
  s_mov_b32 s45, s31
  s_mov_b32 s46, 2097152
  s_mov_b32 s47, 0x20000
  buffer_store_dwordx4 v[8:11], v24, s[44:47], 0 offen sc1
  s_mov_b32 exec_hi, 0xffff
  buffer_store_dwordx4 v[8:11], v12, s[44:47], 0 offen sc1
  buffer_store_dwordx4 v[8:11], v13, s[44:47], 0 offen sc1
  s_mov_b32 s32, s8
  s_mov_b32 s33, s9
  s_mov_b32 s34, 1280
  s_mov_b32 s35, 0x20000
  s_mov_b32 s48, s28
  s_mov_b32 s49, s29
  s_mov_b32 s50, 256
  s_mov_b32 s51, 0x20000
  s_mov_b64 exec, -1
  buffer_load_dword v4, v1, s[32:35], 0 offen
  buffer_load_dword v5, v1, s[32:35], 0 offen offset:256
  buffer_load_dword v6, v1, s[32:35], 0 offen offset:512
  buffer_load_dword v7, v1, s[32:35], 0 offen offset:768
  buffer_load_dword v8, v1, s[32:35], 0 offen offset:1024
  s_waitcnt lgkmcnt(0)
  s_barrier
  s_getreg_b32 s6, hwreg(HW_REG_XCC_ID, 0, 4)
  s_mul_i32 s56, s6, s6
  s_lshl_b32 s56, s56, 16
  s_lshl_b32 s6, s6, 8
  s_add_u32 s6, s6, s56
  s_add_u32 s63, s6, 1
  s_lshl_b32 s6, s4, 3
  v_mov_b32 v12, s6
  v_mov_b32 v13, s63
  v_mov_b32 v14, 0
  v_mov_b32 v15, 1
  s_waitcnt vmcnt(5)
  s_mov_b64 exec, 1
  buffer_atomic_add v13, v12, s[48:51], 0 offen sc1
  ds_write_b32 v14, v15 offset:396
  s_mov_b64 exec, -1
  s_waitcnt vmcnt(1)
  v_lshlrev_b32 v10, 16, v4
  v_and_b32 v11, 0xffff0000, v4
  v_lshlrev_b32 v12, 16, v5
  v_and_b32 v13, 0xffff0000, v5
  v_lshlrev_b32 v14, 16, v6
  v_and_b32 v15, 0xffff0000, v6
  v_lshlrev_b32 v16, 16, v7
  v_and_b32 v17, 0xffff0000, v7
  v_lshlrev_b32 v18, 16, v8
  v_and_b32 v19, 0xffff0000, v8
  v_add_f32 v20, v10, v11
  v_add_f32 v20, v20, v12
  v_add_f32 v20, v20, v13
  v_add_f32 v20, v20, v14
  v_add_f32 v20, v20, v15
  v_add_f32 v20, v20, v16
  v_add_f32 v20, v20, v17
  v_add_f32 v20, v20, v18
  v_add_f32 v20, v20, v19
  s_nop 1
  v_add_f32_dpp v20, v20, v20 row_ror:1 row_mask:0xf bank_mask:0xf
  s_nop 1
  v_add_f32_dpp v20, v20, v20 row_ror:2 row_mask:0xf bank_mask:0xf
  s_nop 1
  v_add_f32_dpp v20, v20, v20 row_ror:4 row_mask:0xf bank_mask:0xf
  s_nop 1
  v_add_f32_dpp v20, v20, v20 row_ror:8 row_mask:0xf bank_mask:0xf
  v_mov_b32 v21, v20
  s_nop 1
  v_permlane16_swap_b32 v20, v21
  v_add_f32 v20, v20, v21
  v_mov_b32 v21, v20
  s_nop 1
  v_permlane32_swap_b32 v20, v21
  v_add_f32 v20, v20, v21
  v_mul_f32 v22, 0x3acccccd, v20
  v_sub_f32 v21, v10, v22
  v_mul_f32 v20, v21, v21
  v_sub_f32 v21, v11, v22
  v_fmac_f32 v20, v21, v21
  v_sub_f32 v21, v12, v22
  v_fmac_f32 v20, v21, v21
  v_sub_f32 v21, v13, v22
  v_fmac_f32 v20, v21, v21
  v_sub_f32 v21, v14, v22
  v_fmac_f32 v20, v21, v21
  v_sub_f32 v21, v15, v22
  v_fmac_f32 v20, v21, v21
  v_sub_f32 v21, v16, v22
  v_fmac_f32 v20, v21, v21
  v_sub_f32 v21, v17, v22
  v_fmac_f32 v20, v21, v21
  v_sub_f32 v21, v18, v22
  v_fmac_f32 v20, v21, v21
  v_sub_f32 v21, v19, v22
  v_fmac_f32 v20, v21, v21
  s_nop 1
  v_add_f32_dpp v20, v20, v20 row_ror:1 row_mask:0xf bank_mask:0xf
  s_nop 1
  v_add_f32_dpp v20, v20, v20 row_ror:2 row_mask:0xf bank_mask:0xf
  s_nop 1
  v_add_f32_dpp v20, v20, v20 row_ror:4 row_mask:0xf bank_mask:0xf
  s_nop 1
  v_add_f32_dpp v20, v20, v20 row_ror:8 row_mask:0xf bank_mask:0xf
  v_mov_b32 v21, v20
  s_nop 1
  v_permlane16_swap_b32 v20, v21
  v_add_f32 v20, v20, v21
  v_mov_b32 v21, v20
  s_nop 1
  v_permlane32_swap_b32 v20, v21
  v_add_f32 v20, v20, v21
  v_mul_f32 v20, 0x3acccccd, v20
  v_cvt_pk_bf16_f32 v21, v20, v22
  v_lshlrev_b32 v20, 16, v21
  v_and_b32 v22, 0xffff0000, v21
  v_add_f32 v20, 0x3727c5ac, v20
  v_cvt_pk_bf16_f32 v20, v20, v20
  v_lshlrev_b32 v20, 16, v20
  v_sqrt_f32 v20, v20
  s_nop 0
  v_cvt_pk_bf16_f32 v20, v20, v20
  v_lshlrev_b32 v20, 16, v20
  v_rcp_f32 v20, v20
  v_sub_f32 v10, v10, v22
  v_sub_f32 v11, v11, v22
  v_sub_f32 v12, v12, v22
  v_sub_f32 v13, v13, v22
  v_sub_f32 v14, v14, v22
  v_sub_f32 v15, v15, v22
  v_sub_f32 v16, v16, v22
  v_sub_f32 v17, v17, v22
  v_sub_f32 v18, v18, v22
  v_sub_f32 v19, v19, v22
  v_cvt_pk_bf16_f32 v4, v10, v11
  v_cvt_pk_bf16_f32 v5, v12, v13
  v_cvt_pk_bf16_f32 v6, v14, v15
  v_cvt_pk_bf16_f32 v7, v16, v17
  v_cvt_pk_bf16_f32 v8, v18, v19
  v_lshlrev_b32 v10, 16, v4
  v_and_b32 v11, 0xffff0000, v4
  v_lshlrev_b32 v12, 16, v5
  v_and_b32 v13, 0xffff0000, v5
  v_lshlrev_b32 v14, 16, v6
  v_and_b32 v15, 0xffff0000, v6
  v_lshlrev_b32 v16, 16, v7
  v_and_b32 v17, 0xffff0000, v7
  v_lshlrev_b32 v18, 16, v8
  v_and_b32 v19, 0xffff0000, v8
  v_mul_f32 v10, v10, v20
  v_mul_f32 v11, v11, v20
  v_mul_f32 v12, v12, v20
  v_mul_f32 v13, v13, v20
  v_mul_f32 v14, v14, v20
  v_mul_f32 v15, v15, v20
  v_mul_f32 v16, v16, v20
  v_mul_f32 v17, v17, v20
  v_mul_f32 v18, v18, v20
  v_mul_f32 v19, v19, v20
  v_cvt_pk_bf16_f32 v4, v10, v11
  v_cvt_pk_bf16_f32 v5, v12, v13
  v_cvt_pk_bf16_f32 v6, v14, v15
  v_cvt_pk_bf16_f32 v7, v16, v17
  v_cvt_pk_bf16_f32 v8, v18, v19
  v_lshlrev_b32 v21, 2, v0
  ds_write_b32 v21, v4 offset:1280
  ds_write_b32 v21, v5 offset:1536
  ds_write_b32 v21, v6 offset:1792
  ds_write_b32 v21, v7 offset:2048
  ds_write_b32 v21, v8 offset:2304
  v_lshrrev_b32 v20, 3, v0
  s_mul_i32 s6, s64, 64
  v_add_u32 v20, s6, v20
  v_lshlrev_b32 v20, 1, v20
  s_waitcnt lgkmcnt(0)
  ds_read_u16 v24, v20 offset:1280
  ds_read_u16 v25, v20 offset:1296
  ds_read_u16 v26, v20 offset:1312
  ds_read_u16 v27, v20 offset:1328
  ds_read_u16 v28, v20 offset:1344
  ds_read_u16 v29, v20 offset:1360
  ds_read_u16 v30, v20 offset:1376
  ds_read_u16 v31, v20 offset:1392
  s_waitcnt lgkmcnt(0)
  v_lshlrev_b32 v34, 16, v24
  v_lshlrev_b32 v35, 16, v25
  v_lshlrev_b32 v36, 16, v26
  v_lshlrev_b32 v37, 16, v27
  v_lshlrev_b32 v38, 16, v28
  v_lshlrev_b32 v39, 16, v29
  v_lshlrev_b32 v40, 16, v30
  v_lshlrev_b32 v41, 16, v31
  v_lshlrev_b32 v12, 3, v0
  v_mov_b32 v14, 0
  s_mov_b32 s57, 0
  s_sleep 35
  s_lshl_b32 s6, s4, 3
  v_mov_b32 v62, s6
  s_mov_b64 exec, 1
L_cntpoll_46:
  buffer_load_dword v60, v62, s[48:51], 0 offen sc1
  s_add_u32 s57, s57, 1
  s_cmp_gt_u32 s57, 30000
  s_waitcnt vmcnt(0)
  v_readfirstlane_b32 s58, v60
  s_cbranch_scc1 L_cntpolld_47
  s_and_b32 s6, s58, 0xff
  s_cmp_eq_u32 s6, 8
  s_cbranch_scc1 L_cntpolld_47
  s_sleep 10
  s_branch L_cntpoll_46
L_cntpolld_47:
  s_lshl_b32 s6, s63, 3
  s_cmp_eq_u32 s58, s6
  s_cselect_b32 s59, 2, 1
  v_mov_b32 v13, s59
  s_mov_b64 vcc, -1
  s_mov_b64 exec, 1
  ds_write_b32 v14, v13 offset:384
  s_mov_b64 exec, -1
  s_mov_b64 s[54:55], vcc
  s_cmp_lg_u32 s66, 0
  s_cbranch_scc1 L_ffn_48
  s_cmp_eq_u64 s[54:55], 0
  s_cbranch_scc1 L_allcntd_50
  s_mov_b32 s57, 0
  s_mov_b32 exec_hi, 0
L_allcnt_49:
  buffer_load_dword v60, v12, s[48:51], 0 offen sc1
  s_add_u32 s57, s57, 1
  s_cmp_gt_u32 s57, 30000
  s_waitcnt vmcnt(0)
  s_cbranch_scc1 L_allcntd_50
  v_and_b32 v61, 0xff, v60
  v_cmp_ne_u32 vcc, 8, v61
  s_cbranch_vccnz L_allcnt_49
L_allcntd_50:
  v_mov_b32 v13, 1
  v_mov_b32 v14, 0
  s_mov_b64 exec, 1
  ds_write_b32 v14, v13 offset:464
  s_mov_b64 exec, -1
  s_waitcnt lgkmcnt(0)
  s_branch L_exit_stamped
L_ffn_48:
  s_setprio 0
  s_mul_i32 s6, s64, 196608
  s_lshl_b32 s56, s65, 7
  s_add_u32 s6, s6, s56
  s_add_u32 s36, s20, s6
  s_addc_u32 s37, s21, 0
  s_mov_b32 s38, 193664
  s_mov_b32 s39, 0x20000
  s_add_u32 s40, s22, s6
  s_addc_u32 s41, s23, 0
  s_mov_b32 s42, 193664
  s_mov_b32 s43, 0x20000
  v_lshrrev_b32 v2, 3, v0
  v_and_b32 v3, 7, v0
  v_mul_u32_u24 v9, 1280, v2
  v_lshl_add_u32 v9, v3, 4, v9
  v_mul_u32_u24 v2, 3072, v2
  v_lshl_add_u32 v2, v3, 4, v2
  s_mov_b32 s6, 0
  buffer_load_dwordx4 v[64:67], v2, s[36:39], s6 offen nt
  s_mov_b32 s6, 24576
  buffer_load_dwordx4 v[68:71], v2, s[36:39], s6 offen nt
  s_mov_b32 s6, 49152
  buffer_load_dwordx4 v[72:75], v2, s[36:39], s6 offen nt
  s_mov_b32 s6, 73728
  buffer_load_dwordx4 v[76:79], v2, s[36:39], s6 offen nt
  s_mov_b32 s6, 98304
  buffer_load_dwordx4 v[80:83], v2, s[36:39], s6 offen nt
  s_mov_b32 s6, 122880
  buffer_load_dwordx4 v[84:87], v2, s[36:39], s6 offen nt
  s_mov_b32 s6, 147456
  buffer_load_dwordx4 v[88:91], v2, s[36:39], s6 offen nt
  s_mov_b32 s6, 172032
  buffer_load_dwordx4 v[92:95], v2, s[36:39], s6 offen nt
  s_mov_b32 s6, 0
  buffer_load_dwordx4 v[96:99], v2, s[40:43], s6 offen nt
  s_mov_b32 s6, 24576
  buffer_load_dwordx4 v[100:103], v2, s[40:43], s6 offen nt
  s_mov_b32 s6, 49152
  buffer_load_dwordx4 v[104:107], v2, s[40:43], s6 offen nt
  s_mov_b32 s6, 73728
  buffer_load_dwordx4 v[108:111], v2, s[40:43], s6 offen nt
  s_mov_b32 s6, 98304
  buffer_load_dwordx4 v[112:115], v2, s[40:43], s6 offen nt
  s_mov_b32 s6, 122880
  buffer_load_dwordx4 v[116:119], v2, s[40:43], s6 offen nt
  s_mov_b32 s6, 147456
  buffer_load_dwordx4 v[120:123], v2, s[40:43], s6 offen nt
  s_mov_b32 s6, 172032
  buffer_load_dwordx4 v[124:127], v2, s[40:43], s6 offen nt
  s_mul_i32 s6, s65, 81920
  s_lshl_b32 s56, s64, 7
  s_add_u32 s6, s6, s56
  s_add_u32 s36, s24, s6
  s_addc_u32 s37, s25, 0
  s_mov_b32 s38, 80768
  s_mov_b32 s39, 0x20000
  s_waitcnt vmcnt(8)
  v_dot2_f32_bf16 v44, v64, v24, 0
  v_dot2_f32_bf16 v45, v64, v34, 0
  v_dot2_f32_bf16 v46, v65, v24, 0
  v_dot2_f32_bf16 v47, v65, v34, 0
  v_dot2_f32_bf16 v48, v66, v24, 0
  v_dot2_f32_bf16 v49, v66, v34, 0
  v_dot2_f32_bf16 v50, v67, v24, 0
  v_dot2_f32_bf16 v51, v67, v34, 0
  v_dot2_f32_bf16 v44, v68, v25, v44
  v_dot2_f32_bf16 v45, v68, v35, v45
  v_dot2_f32_bf16 v46, v69, v25, v46
  v_dot2_f32_bf16 v47, v69, v35, v47
  v_dot2_f32_bf16 v48, v70, v25, v48
  v_dot2_f32_bf16 v49, v70, v35, v49
  v_dot2_f32_bf16 v50, v71, v25, v50
  v_dot2_f32_bf16 v51, v71, v35, v51
  v_dot2_f32_bf16 v44, v72, v26, v44
  v_dot2_f32_bf16 v45, v72, v36, v45
  v_dot2_f32_bf16 v46, v73, v26, v46
  v_dot2_f32_bf16 v47, v73, v36, v47
  v_dot2_f32_bf16 v48, v74, v26, v48
  v_dot2_f32_bf16 v49, v74, v36, v49
  v_dot2_f32_bf16 v50, v75, v26, v50
  v_dot2_f32_bf16 v51, v75, v36, v51
  v_dot2_f32_bf16 v44, v76, v27, v44
  v_dot2_f32_bf16 v45, v76, v37, v45
  v_dot2_f32_bf16 v46, v77, v27, v46
  v_dot2_f32_bf16 v47, v77, v37, v47
  v_dot2_f32_bf16 v48, v78, v27, v48
  v_dot2_f32_bf16 v49, v78, v37, v49
  v_dot2_f32_bf16 v50, v79, v27, v50
  v_dot2_f32_bf16 v51, v79, v37, v51
  v_dot2_f32_bf16 v44, v80, v28, v44
  v_dot2_f32_bf16 v45, v80, v38, v45
  v_dot2_f32_bf16 v46, v81, v28, v46
  v_dot2_f32_bf16 v47, v81, v38, v47
  v_dot2_f32_bf16 v48, v82, v28, v48
  v_dot2_f32_bf16 v49, v82, v38, v49
  v_dot2_f32_bf16 v50, v83, v28, v50
  v_dot2_f32_bf16 v51, v83, v38, v51
  v_dot2_f32_bf16 v44, v84, v29, v44
  v_dot2_f32_bf16 v45, v84, v39, v45
  v_dot2_f32_bf16 v46, v85, v29, v46
  v_dot2_f32_bf16 v47, v85, v39, v47
  v_dot2_f32_bf16 v48, v86, v29, v48
  v_dot2_f32_bf16 v49, v86, v39, v49
  v_dot2_f32_bf16 v50, v87, v29, v50
  v_dot2_f32_bf16 v51, v87, v39, v51
  v_dot2_f32_bf16 v44, v88, v30, v44
  v_dot2_f32_bf16 v45, v88, v40, v45
  v_dot2_f32_bf16 v46, v89, v30, v46
  v_dot2_f32_bf16 v47, v89, v40, v47
  v_dot2_f32_bf16 v48, v90, v30, v48
  v_dot2_f32_bf16 v49, v90, v40, v49
  v_dot2_f32_bf16 v50, v91, v30, v50
  v_dot2_f32_bf16 v51, v91, v40, v51
  v_dot2_f32_bf16 v44, v92, v31, v44
  v_dot2_f32_bf16 v45, v92, v41, v45
  v_dot2_f32_bf16 v46, v93, v31, v46
  v_dot2_f32_bf16 v47, v93, v41, v47
  v_dot2_f32_bf16 v48, v94, v31, v48
  v_dot2_f32_bf16 v49, v94, v41, v49
  v_dot2_f32_bf16 v50, v95, v31, v50
  v_dot2_f32_bf16 v51, v95, v41, v51
  s_waitcnt vmcnt(0)
  v_dot2_f32_bf16 v52, v96, v24, 0
  v_dot2_f32_bf16 v53, v96, v34, 0
  v_dot2_f32_bf16 v54, v97, v24, 0
  v_dot2_f32_bf16 v55, v97, v34, 0
  v_dot2_f32_bf16 v56, v98, v24, 0
  v_dot2_f32_bf16 v57, v98, v34, 0
  v_dot2_f32_bf16 v58, v99, v24, 0
  v_dot2_f32_bf16 v59, v99, v34, 0
  v_dot2_f32_bf16 v52, v100, v25, v52
  v_dot2_f32_bf16 v53, v100, v35, v53
  v_dot2_f32_bf16 v54, v101, v25, v54
  v_dot2_f32_bf16 v55, v101, v35, v55
  v_dot2_f32_bf16 v56, v102, v25, v56
  v_dot2_f32_bf16 v57, v102, v35, v57
  v_dot2_f32_bf16 v58, v103, v25, v58
  v_dot2_f32_bf16 v59, v103, v35, v59
  v_dot2_f32_bf16 v52, v104, v26, v52
  v_dot2_f32_bf16 v53, v104, v36, v53
  v_dot2_f32_bf16 v54, v105, v26, v54
  v_dot2_f32_bf16 v55, v105, v36, v55
  v_dot2_f32_bf16 v56, v106, v26, v56
  v_dot2_f32_bf16 v57, v106, v36, v57
  v_dot2_f32_bf16 v58, v107, v26, v58
  v_dot2_f32_bf16 v59, v107, v36, v59
  v_dot2_f32_bf16 v52, v108, v27, v52
  v_dot2_f32_bf16 v53, v108, v37, v53
  v_dot2_f32_bf16 v54, v109, v27, v54
  v_dot2_f32_bf16 v55, v109, v37, v55
  v_dot2_f32_bf16 v56, v110, v27, v56
  v_dot2_f32_bf16 v57, v110, v37, v57
  v_dot2_f32_bf16 v58, v111, v27, v58
  v_dot2_f32_bf16 v59, v111, v37, v59
  v_dot2_f32_bf16 v52, v112, v28, v52
  v_dot2_f32_bf16 v53, v112, v38, v53
  v_dot2_f32_bf16 v54, v113, v28, v54
  v_dot2_f32_bf16 v55, v113, v38, v55
  v_dot2_f32_bf16 v56, v114, v28, v56
  v_dot2_f32_bf16 v57, v114, v38, v57
  v_dot2_f32_bf16 v58, v115, v28, v58
  v_dot2_f32_bf16 v59, v115, v38, v59
  v_dot2_f32_bf16 v52, v116, v29, v52
  v_dot2_f32_bf16 v53, v116, v39, v53
  v_dot2_f32_bf16 v54, v117, v29, v54
  v_dot2_f32_bf16 v55, v117, v39, v55
  v_dot2_f32_bf16 v56, v118, v29, v56
  v_dot2_f32_bf16 v57, v118, v39, v57
  v_dot2_f32_bf16 v58, v119, v29, v58
  v_dot2_f32_bf16 v59, v119, v39, v59
  v_dot2_f32_bf16 v52, v120, v30, v52
  v_dot2_f32_bf16 v53, v120, v40, v53
  v_dot2_f32_bf16 v54, v121, v30, v54
  v_dot2_f32_bf16 v55, v121, v40, v55
  v_dot2_f32_bf16 v56, v122, v30, v56
  v_dot2_f32_bf16 v57, v122, v40, v57
  v_dot2_f32_bf16 v58, v123, v30, v58
  v_dot2_f32_bf16 v59, v123, v40, v59
  v_dot2_f32_bf16 v52, v124, v31, v52
  v_dot2_f32_bf16 v53, v124, v41, v53
  v_dot2_f32_bf16 v54, v125, v31, v54
  v_dot2_f32_bf16 v55, v125, v41, v55
  v_dot2_f32_bf16 v56, v126, v31, v56
  v_dot2_f32_bf16 v57, v126, v41, v57
  v_dot2_f32_bf16 v58, v127, v31, v58
  v_dot2_f32_bf16 v59, v127, v41, v59
  s_mov_b32 s6, 0
  buffer_load_dwordx4 v[64:67], v9, s[36:39], s6 offen nt
  s_mov_b32 s6, 10240
  buffer_load_dwordx4 v[68:71], v9, s[36:39], s6 offen nt
  s_mov_b32 s6, 20480
  buffer_load_dwordx4 v[72:75], v9, s[36:39], s6 offen nt
  s_mov_b32 s6, 30720
  buffer_load_dwordx4 v[76:79], v9, s[36:39], s6 offen nt
  s_mov_b32 s6, 40960
  buffer_load_dwordx4 v[80:83], v9, s[36:39], s6 offen nt
  s_mov_b32 s6, 51200
  buffer_load_dwordx4 v[84:87], v9, s[36:39], s6 offen nt
  s_mov_b32 s6, 61440
  buffer_load_dwordx4 v[88:91], v9, s[36:39], s6 offen nt
  s_mov_b32 s6, 71680
  buffer_load_dwordx4 v[92:95], v9, s[36:39], s6 offen nt
  v_permlane32_swap_b32 v44, v48
  v_permlane32_swap_b32 v45, v49
  v_permlane32_swap_b32 v46, v50
  v_permlane32_swap_b32 v47, v51
  v_add_f32 v44, v44, v48
  v_add_f32 v45, v45, v49
  v_add_f32 v46, v46, v50
  v_add_f32 v47, v47, v51
  s_nop 0
  v_permlane16_swap_b32 v44, v46
  v_permlane16_swap_b32 v45, v47
  v_add_f32 v44, v44, v46
  v_add_f32 v45, v45, v47
  s_nop 0
  v_add_f32_dpp v21, v44, v44 row_ror:8 row_mask:0xf bank_mask:0x3
  s_nop 1
  v_add_f32_dpp v21, v45, v45 row_ror:8 row_mask:0xf bank_mask:0xc
  v_permlane32_swap_b32 v52, v56
  v_permlane32_swap_b32 v53, v57
  v_permlane32_swap_b32 v54, v58
  v_permlane32_swap_b32 v55, v59
  v_add_f32 v52, v52, v56
  v_add_f32 v53, v53, v57
  v_add_f32 v54, v54, v58
  v_add_f32 v55, v55, v59
  s_nop 0
  v_permlane16_swap_b32 v52, v54
  v_permlane16_swap_b32 v53, v55
  v_add_f32 v52, v52, v54
  v_add_f32 v53, v53, v55
  s_nop 0
  v_add_f32_dpp v22, v52, v52 row_ror:8 row_mask:0xf bank_mask:0x3
  s_nop 1
  v_add_f32_dpp v22, v53, v53 row_ror:8 row_mask:0xf bank_mask:0xc
  v_min_u32 v21, -2, v21
  v_min_u32 v22, -2, v22
  v_add_u32 v15, s67, v1
  buffer_store_dword v21, v15, s[44:47], 0 offen sc1
  buffer_store_dword v22, v15, s[44:47], 0 offen offset:256 sc1
  s_cmp_eq_u64 s[54:55], 0
  s_cbranch_scc1 L_allcntd_52
  s_mov_b32 s57, 0
  s_mov_b32 exec_hi, 0
L_allcnt_51:
  buffer_load_dword v60, v12, s[48:51], 0 offen sc1
  s_add_u32 s57, s57, 1
  s_cmp_gt_u32 s57, 30000
  s_waitcnt vmcnt(0)
  s_cbranch_scc1 L_allcntd_52
  v_and_b32 v61, 0xff, v60
  v_cmp_ne_u32 vcc, 8, v61
  s_cbranch_vccnz L_allcnt_51
L_allcntd_52:
  v_mov_b32 v13, 1
  v_mov_b32 v14, 0
  s_mov_b64 exec, 1
  ds_write_b32 v14, v13 offset:464
  s_mov_b64 exec, -1
  s_mul_i32 s6, s65, 7680
  s_add_u32 s6, s6, 327680
  v_lshrrev_b32 v14, 5, v0
  v_mul_u32_u24 v14, 768, v14
  v_and_b32 v15, 31, v0
  v_lshl_add_u32 v14, v15, 4, v14
  v_add_u32 v14, s6, v14
  v_add_u32 v15, 4608, v14
  v_mul_u32_u24 v16, 768, v0
  v_add_u32 v16, s6, v16
  s_mov_b64 exec, 0x3ff
  s_mov_b32 s57, 0
L_preF_53:
  buffer_load_dword v128, v16, s[44:47], 0 offen offset:508 sc1
  s_waitcnt vmcnt(0)
  v_cmp_eq_u32 vcc, -1, v128
  s_add_u32 s57, s57, 1
  s_cmp_gt_u32 s57, 30000
  s_cbranch_scc1 L_preFd_54
  s_cbranch_vccz L_preFd_54
  s_sleep 8
  s_branch L_preF_53
L_preFd_54:
  s_mov_b64 exec, -1
  s_mov_b32 s57, 0
L_pollF_55:
  buffer_load_dwordx4 v[128:131], v14, s[44:47], 0 offen sc1
  buffer_load_dwordx4 v[132:135], v14, s[44:47], 0 offen offset:1536 sc1
  buffer_load_dwordx4 v[136:139], v14, s[44:47], 0 offen offset:3072 sc1
  buffer_load_dwordx4 v[140:143], v15, s[44:47], 0 offen sc1
  buffer_load_dwordx4 v[144:147], v15, s[44:47], 0 offen offset:1536 sc1
  s_waitcnt vmcnt(0)
  v_max3_u32 v148, v128, v129, v130
  v_max3_u32 v148, v148, v131, v132
  v_max3_u32 v148, v148, v133, v134
  v_max3_u32 v148, v148, v135, v136
  v_max3_u32 v148, v148, v137, v138
  v_max3_u32 v148, v148, v139, v140
  v_max3_u32 v148, v148, v141, v142
  v_max3_u32 v148, v148, v143, v144
  v_max3_u32 v148, v148, v145, v146
  v_max_u32 v148, v148, v147
  v_cmp_eq_u32 vcc, -1, v148
  s_add_u32 s57, s57, 1
  s_cmp_gt_u32 s57, 30000
  s_cbranch_scc1 L_pollFd_56
  s_cbranch_vccz L_pollFd_56
  s_sleep 4
  s_branch L_pollF_55
L_pollFd_56:
  v_add_f32 v128, v128, v132
  v_add_f32 v136, v136, v140
  v_add_f32 v129, v129, v133
  v_add_f32 v137, v137, v141
  v_add_f32 v130, v130, v134
  v_add_f32 v138, v138, v142
  v_add_f32 v131, v131, v135
  v_add_f32 v139, v139, v143
  v_add_f32 v128, v128, v144
  v_add_f32 v129, v129, v145
  v_add_f32 v130, v130, v146
  v_add_f32 v131, v131, v147
  v_add_f32 v128, v128, v136
  v_add_f32 v129, v129, v137
  v_add_f32 v130, v130, v138
  v_add_f32 v131, v131, v139
  v_mov_b32 v132, v128
  v_mov_b32 v133, v129
  v_mov_b32 v134, v130
  v_mov_b32 v135, v131
  v_permlane32_swap_b32 v128, v132
  v_permlane32_swap_b32 v129, v133
  v_permlane32_swap_b32 v130, v134
  v_permlane32_swap_b32 v131, v135
  v_add_f32 v128, v128, v132
  v_add_f32 v129, v129, v133
  v_add_f32 v130, v130, v134
  v_add_f32 v131, v131, v135
  v_mov_b32 v132, v128
  v_mov_b32 v133, v129
  v_mov_b32 v134, v130
  v_mov_b32 v135, v131
  v_permlane16_swap_b32 v128, v132
  v_permlane16_swap_b32 v129, v133
  v_permlane16_swap_b32 v130, v134
  v_permlane16_swap_b32 v131, v135
  v_cvt_pk_bf16_f32 v128, v128, v132
  v_cvt_pk_bf16_f32 v129, v129, v133
  v_cvt_pk_bf16_f32 v130, v130, v134
  v_cvt_pk_bf16_f32 v131, v131, v135
  v_lshlrev_b32 v132, 16, v128
  v_and_b32 v128, 0xffff0000, v128
  v_lshlrev_b32 v133, 16, v129
  v_and_b32 v129, 0xffff0000, v129
  v_lshlrev_b32 v134, 16, v130
  v_and_b32 v130, 0xffff0000, v130
  v_lshlrev_b32 v135, 16, v131
  v_and_b32 v131, 0xffff0000, v131
  v_max_f32 v132, 0, v132
  v_max_f32 v133, 0, v133
  v_max_f32 v134, 0, v134
  v_max_f32 v135, 0, v135
  v_mul_f32 v128, v132, v128
  v_mul_f32 v129, v133, v129
  v_mul_f32 v130, v134, v130
  v_mul_f32 v131, v135, v131
  v_cvt_pk_bf16_f32 v128, v128, v128
  v_cvt_pk_bf16_f32 v129, v129, v129
  v_cvt_pk_bf16_f32 v130, v130, v130
  v_cvt_pk_bf16_f32 v131, v131, v131
  v_and_b32 v18, 1, v0
  v_lshlrev_b32 v18, 5, v18
  v_bfe_u32 v19, v0, 1, 3
  v_add_u32 v18, v18, v19
  v_lshlrev_b32 v18, 1, v18
  s_mov_b32 exec_lo, 0xffff
  s_mov_b32 exec_hi, 0
  ds_write_b16 v18, v128 offset:2560
  ds_write_b16 v18, v129 offset:2576
  ds_write_b16 v18, v130 offset:2592
  ds_write_b16 v18, v131 offset:2608
  s_mov_b64 exec, -1
  v_lshrrev_b32 v18, 3, v0
  v_lshlrev_b32 v18, 1, v18
  s_waitcnt lgkmcnt(0)
  ds_read_u16 v24, v18 offset:2560
  ds_read_u16 v25, v18 offset:2576
  ds_read_u16 v26, v18 offset:2592
  ds_read_u16 v27, v18 offset:2608
  ds_read_u16 v28, v18 offset:2624
  ds_read_u16 v29, v18 offset:2640
  ds_read_u16 v30, v18 offset:2656
  ds_read_u16 v31, v18 offset:2672
  v_bfe_u32 v19, v0, 1, 2
  v_mul_u32_u24 v19, 8448, v19
  v_and_b32 v20, 1, v0
  v_lshl_add_u32 v19, v20, 5, v19
  v_lshrrev_b32 v20, 3, v0
  v_lshl_add_u32 v19, v20, 2, v19
  v_add_u32 v19, s68, v19
  s_waitcnt lgkmcnt(0)
  v_lshlrev_b32 v34, 16, v24
  v_lshlrev_b32 v35, 16, v25
  v_lshlrev_b32 v36, 16, v26
  v_lshlrev_b32 v37, 16, v27
  v_lshlrev_b32 v38, 16, v28
  v_lshlrev_b32 v39, 16, v29
  v_lshlrev_b32 v40, 16, v30
  v_lshlrev_b32 v41, 16, v31
  s_waitcnt vmcnt(0)
  v_dot2_f32_bf16 v44, v64, v24, 0
  v_dot2_f32_bf16 v45, v64, v34, 0
  v_dot2_f32_bf16 v46, v65, v24, 0
  v_dot2_f32_bf16 v47, v65, v34, 0
  v_dot2_f32_bf16 v48, v66, v24, 0
  v_dot2_f32_bf16 v49, v66, v34, 0
  v_dot2_f32_bf16 v50, v67, v24, 0
  v_dot2_f32_bf16 v51, v67, v34, 0
  v_dot2_f32_bf16 v44, v68, v25, v44
  v_dot2_f32_bf16 v45, v68, v35, v45
  v_dot2_f32_bf16 v46, v69, v25, v46
  v_dot2_f32_bf16 v47, v69, v35, v47
  v_dot2_f32_bf16 v48, v70, v25, v48
  v_dot2_f32_bf16 v49, v70, v35, v49
  v_dot2_f32_bf16 v50, v71, v25, v50
  v_dot2_f32_bf16 v51, v71, v35, v51
  v_dot2_f32_bf16 v44, v72, v26, v44
  v_dot2_f32_bf16 v45, v72, v36, v45
  v_dot2_f32_bf16 v46, v73, v26, v46
  v_dot2_f32_bf16 v47, v73, v36, v47
  v_dot2_f32_bf16 v48, v74, v26, v48
  v_dot2_f32_bf16 v49, v74, v36, v49
  v_dot2_f32_bf16 v50, v75, v26, v50
  v_dot2_f32_bf16 v51, v75, v36, v51
  v_dot2_f32_bf16 v44, v76, v27, v44
  v_dot2_f32_bf16 v45, v76, v37, v45
  v_dot2_f32_bf16 v46, v77, v27, v46
  v_dot2_f32_bf16 v47, v77, v37, v47
  v_dot2_f32_bf16 v48, v78, v27, v48
  v_dot2_f32_bf16 v49, v78, v37, v49
  v_dot2_f32_bf16 v50, v79, v27, v50
  v_dot2_f32_bf16 v51, v79, v37, v51
  v_dot2_f32_bf16 v44, v80, v28, v44
  v_dot2_f32_bf16 v45, v80, v38, v45
  v_dot2_f32_bf16 v46, v81, v28, v46
  v_dot2_f32_bf16 v47, v81, v38, v47
  v_dot2_f32_bf16 v48, v82, v28, v48
  v_dot2_f32_bf16 v49, v82, v38, v49
  v_dot2_f32_bf16 v50, v83, v28, v50
  v_dot2_f32_bf16 v51, v83, v38, v51
  v_dot2_f32_bf16 v44, v84, v29, v44
  v_dot2_f32_bf16 v45, v84, v39, v45
  v_dot2_f32_bf16 v46, v85, v29, v46
  v_dot2_f32_bf16 v47, v85, v39, v47
  v_dot2_f32_bf16 v48, v86, v29, v48
  v_dot2_f32_bf16 v49, v86, v39, v49
  v_dot2_f32_bf16 v50, v87, v29, v50
  v_dot2_f32_bf16 v51, v87, v39, v51
  v_dot2_f32_bf16 v44, v88, v30, v44
  v_dot2_f32_bf16 v45, v88, v40, v45
  v_dot2_f32_bf16 v46, v89, v30, v46
  v_dot2_f32_bf16 v47, v89, v40, v47
  v_dot2_f32_bf16 v48, v90, v30, v48
  v_dot2_f32_bf16 v49, v90, v40, v49
  v_dot2_f32_bf16 v50, v91, v30, v50
  v_dot2_f32_bf16 v51, v91, v40, v51
  v_dot2_f32_bf16 v44, v92, v31, v44
  v_dot2_f32_bf16 v45, v92, v41, v45
  v_dot2_f32_bf16 v46, v93, v31, v46
  v_dot2_f32_bf16 v47, v93, v41, v47
  v_dot2_f32_bf16 v48, v94, v31, v48
  v_dot2_f32_bf16 v49, v94, v41, v49
  v_dot2_f32_bf16 v50, v95, v31, v50
  v_dot2_f32_bf16 v51, v95, v41, v51
  v_permlane32_swap_b32 v44, v48
  v_permlane32_swap_b32 v45, v49
  v_permlane32_swap_b32 v46, v50
  v_permlane32_swap_b32 v47, v51
  v_add_f32 v44, v44, v48
  v_add_f32 v45, v45, v49
  v_add_f32 v46, v46, v50
  v_add_f32 v47, v47, v51
  s_nop 0
  v_permlane16_swap_b32 v44, v46
  v_permlane16_swap_b32 v45, v47
  v_add_f32 v44, v44, v46
  v_add_f32 v45, v45, v47
  s_nop 0
  v_add_f32_dpp v21, v44, v44 row_ror:8 row_mask:0xf bank_mask:0x3
  s_nop 1
  v_add_f32_dpp v21, v45, v45 row_ror:8 row_mask:0xf bank_mask:0xc
  v_min_u32 v21, -2, v21
  buffer_store_dword v21, v19, s[44:47], 0 offen sc1
  s_branch L_exit_stamped
L_exit_stamped:
L_end:
  s_endpgm
.section .rodata,"a"
.p2align 6
.amdhsa_kernel recurrent_scan__sliding_block_cached__glu_gated_reglu__decode_kernel
  .amdhsa_next_free_vgpr 168
  .amdhsa_next_free_sgpr 102
  .amdhsa_accum_offset 168
  .amdhsa_group_segment_fixed_size 0
  .amdhsa_kernarg_size 96
  .amdhsa_user_sgpr_count 2
  .amdhsa_user_sgpr_kernarg_segment_ptr 1
  .amdhsa_system_sgpr_workgroup_id_x 1
.end_amdhsa_kernel
```
